```python
import torch

def _softmax(x, axis=-1):
    return torch.softmax(x, dim=axis)
def _gelu(x):
    return torch.nn.functional.gelu(x, approximate="tanh")
def _silu(x):
    return torch.nn.functional.silu(x)
def _sigmoid(x):
    return torch.sigmoid(x)
def _layernorm(x, axis=-1, eps=1e-5):
    m = x.mean(dim=axis, keepdim=True)
    v = x.var(dim=axis, keepdim=True, unbiased=False)
    return (x - m) / torch.sqrt(v + eps)
def _scatter_add(tgt, idx, src, axis=0):
    return tgt.clone().index_add_(axis, idx, src)
def _segment_sum(src, seg, n):
    out = torch.zeros((n,) + src.shape[1:], dtype=src.dtype)
    return out.index_add_(0, seg, src)
def _pad(x, pw):
    flat = tuple(v for pair in reversed(pw) for v in pair)
    return torch.nn.functional.pad(x, flat)

kernel_name = 'sequential_preLN__ssm_conv_s4d__moe_arch_mod__prompt'

def setup_inputs():

    _w = (lambda a: (lambda t: t.to(torch.bfloat16) if t.is_floating_point() else t)(torch.as_tensor(a)))
    def _A_setup():
        Bsz, L, D, N = 1, 2048, 640, 192
        return {
            "u": _w((lambda *s: torch.randn(*s, dtype=torch.bfloat16) * 0.05)(Bsz, L, D)),
            "log_A_real": _w((lambda *s: torch.randn(*s, dtype=torch.bfloat16) * 6.4)(D, N) * 0.5),
            "A_imag": _w((lambda *s: torch.randn(*s, dtype=torch.bfloat16) * 0.05)(D, N) * 3.14),
            "C_real": _w((lambda *s: torch.randn(*s, dtype=torch.bfloat16) * 0.05)(D, N) / N ** 0.5),
            "C_imag": _w((lambda *s: torch.randn(*s, dtype=torch.bfloat16) * 0.05)(D, N) / N ** 0.5),
            "log_dt": _w((lambda *s: torch.randn(*s, dtype=torch.bfloat16) * 0.05)(D) * 0.5 - 4.0),
            "D_skip": _w((lambda *s: torch.randn(*s, dtype=torch.bfloat16) * 0.05)(D)),
        }
    _A_in = _A_setup()

    def _B_setup():
        B, S, D, F, C = 1, 2048, 640, 1536, 8
        return {
            "x": _w((lambda *s: torch.randn(*s, dtype=torch.bfloat16) * 0.05)(B, S, D)),
            "w_r": _w((lambda *s: torch.randn(*s, dtype=torch.bfloat16) * 0.05)(D)),
            "w_gate": _w((lambda *s: torch.randn(*s, dtype=torch.bfloat16) * 0.05)(D, F)),
            "w_up": _w((lambda *s: torch.randn(*s, dtype=torch.bfloat16) * 0.05)(D, F)),
            "w_down": _w((lambda *s: torch.randn(*s, dtype=torch.bfloat16) * 0.05)(F, D)),
        }
    _B_in = _B_setup()

    return {
        "A_u": _A_in["u"],
        "A_log_A_real": _A_in["log_A_real"],
        "A_A_imag": _A_in["A_imag"],
        "A_C_real": _A_in["C_real"],
        "A_C_imag": _A_in["C_imag"],
        "A_log_dt": _A_in["log_dt"],
        "A_D_skip": _A_in["D_skip"],
        "B_x": _B_in["x"],
        "B_w_r": _B_in["w_r"],
        "B_w_gate": _B_in["w_gate"],
        "B_w_up": _B_in["w_up"],
        "B_w_down": _B_in["w_down"],
    }

def reference(A_u, A_log_A_real, A_A_imag, A_C_real, A_C_imag, A_log_dt, A_D_skip, B_x, B_w_r, B_w_gate, B_w_up, B_w_down):
    def _A_ref(u, log_A_real, A_imag, C_real, C_imag, log_dt, D_skip):
        L = u.shape[1]
        dt = torch.exp(log_dt)
        A = -torch.exp(log_A_real) + 1j * A_imag
        C = (C_real + 1j * C_imag) * dt[:, None]
        pos = (lambda x, dt: x.to(dt))(torch.arange(L), log_dt.dtype)
        P = torch.exp((A * dt[:, None])[:, :, None] * pos[None, None, :])
        K = 2.0 * torch.einsum("dn,dnl->dl", C, P).real
        L2 = 2 * L
        u_t = (lambda x, *d: x.permute(*d))(u, 0, 2, 1)
        Kf = (lambda x, *a, **k: torch.fft.rfft(x.float(), *a, **k))(K, L2)
        Uf = (lambda x, *a, **k: torch.fft.rfft(x.float(), *a, **k))(u_t, L2)
        y = (lambda x, *a, **k: torch.fft.irfft(x, *a, **k).to(torch.bfloat16))(Uf * Kf[None, :, :], L2)[:, :, :L]
        y = (lambda x, *d: x.permute(*d))(y, 0, 2, 1)
        return y + u * D_skip[None, None, :]

    def _B_ref(x, w_r, w_gate, w_up, w_down):
        B, S, D = x.shape
        C = 8
        r = x @ w_r
        idx = torch.argsort(-r, axis=-1)[:, :C]
        idx_e = (lambda x, n, axis: torch.repeat_interleave(x, n, dim=axis))(idx.reshape(B, C, 1), D, axis=2)
        x_sel = (lambda x, i, axis: torch.take_along_dim(x, i, dim=axis))(x, idx_e, axis=1)
        g = _silu(x_sel @ w_gate)
        u = x_sel @ w_up
        y = (g * u) @ w_down
        r_sel = _sigmoid((lambda x, i, axis: torch.take_along_dim(x, i, dim=axis))(r, idx, axis=1))
        y = y * r_sel.reshape(B, C, 1)
        b_off = (torch.arange(B) * S).reshape(B, 1)
        flat_idx = (idx + b_off).reshape(B * C)
        zero = (x * 0.0).reshape(B * S, D)
        upd = _scatter_add(zero, flat_idx, y.reshape(B * C, D), axis=0)
        return x + upd.reshape(B, S, D)

    x = A_u
    h = x + _A_ref(_layernorm(x, axis=-1), A_log_A_real, A_A_imag, A_C_real, A_C_imag, A_log_dt, A_D_skip)
    h2 = h + _B_ref(_layernorm(h, axis=-1), B_w_r, B_w_gate, B_w_up, B_w_down)
    return h2
```

```asm
; @launch grid=(256,1,1) block=(256,1,1) lds=141440
.amdgcn_target "amdgcn-amd-amdhsa--gfx950"
.text
.globl sequential_preLN__ssm_conv_s4d__moe_arch_mod__prompt_kernel
.p2align 8
.type sequential_preLN__ssm_conv_s4d__moe_arch_mod__prompt_kernel,@function
sequential_preLN__ssm_conv_s4d__moe_arch_mod__prompt_kernel:
  s_cmp_ge_u32 s2, 256
  s_cbranch_scc1 k_exit
  s_load_dwordx2 s[4:5], s[0:1], 0
  s_load_dwordx2 s[6:7], s[0:1], 112
  s_load_dwordx4 s[44:47], s[0:1], 8
  s_load_dwordx4 s[48:51], s[0:1], 24
  s_load_dwordx4 s[56:59], s[0:1], 40
  s_load_dwordx4 s[60:63], s[0:1], 64
  s_load_dwordx4 s[64:67], s[0:1], 80
  s_load_dwordx4 s[68:71], s[0:1], 96
  s_getpc_b64 s[90:91]
k_pc:
  v_lshlrev_b32 v2, 4, v0
  v_mov_b32 v3, s91
  v_add_co_u32 v2, vcc, s90, v2
  v_addc_co_u32 v3, vcc, 0, v3, vcc
  v_cmp_gt_i32 vcc, (k_code_end-k_pc-0)/16, v0
  s_and_saveexec_b64 s[92:93], vcc
  s_cbranch_execz k_pf_done
  global_load_dwordx4 v[160:163], v[2:3], off
  s_mov_b64 exec, s[92:93]
  v_add_co_u32 v2, vcc, 0x1000, v2
  v_addc_co_u32 v3, vcc, 0, v3, vcc
  v_cmp_gt_i32 vcc, (k_code_end-k_pc-4096)/16, v0
  s_and_saveexec_b64 s[92:93], vcc
  s_cbranch_execz k_pf_done
  global_load_dwordx4 v[160:163], v[2:3], off
  s_mov_b64 exec, s[92:93]
  v_add_co_u32 v2, vcc, 0x1000, v2
  v_addc_co_u32 v3, vcc, 0, v3, vcc
  v_cmp_gt_i32 vcc, (k_code_end-k_pc-8192)/16, v0
  s_and_saveexec_b64 s[92:93], vcc
  s_cbranch_execz k_pf_done
  global_load_dwordx4 v[160:163], v[2:3], off
  s_mov_b64 exec, s[92:93]
  v_add_co_u32 v2, vcc, 0x1000, v2
  v_addc_co_u32 v3, vcc, 0, v3, vcc
  v_cmp_gt_i32 vcc, (k_code_end-k_pc-12288)/16, v0
  s_and_saveexec_b64 s[92:93], vcc
  s_cbranch_execz k_pf_done
  global_load_dwordx4 v[160:163], v[2:3], off
  s_mov_b64 exec, s[92:93]
  v_add_co_u32 v2, vcc, 0x1000, v2
  v_addc_co_u32 v3, vcc, 0, v3, vcc
  v_cmp_gt_i32 vcc, (k_code_end-k_pc-16384)/16, v0
  s_and_saveexec_b64 s[92:93], vcc
  s_cbranch_execz k_pf_done
  global_load_dwordx4 v[160:163], v[2:3], off
  s_mov_b64 exec, s[92:93]
  v_add_co_u32 v2, vcc, 0x1000, v2
  v_addc_co_u32 v3, vcc, 0, v3, vcc
  v_cmp_gt_i32 vcc, (k_code_end-k_pc-20480)/16, v0
  s_and_saveexec_b64 s[92:93], vcc
  s_cbranch_execz k_pf_done
  global_load_dwordx4 v[160:163], v[2:3], off
  s_mov_b64 exec, s[92:93]
  v_add_co_u32 v2, vcc, 0x1000, v2
  v_addc_co_u32 v3, vcc, 0, v3, vcc
  v_cmp_gt_i32 vcc, (k_code_end-k_pc-24576)/16, v0
  s_and_saveexec_b64 s[92:93], vcc
  s_cbranch_execz k_pf_done
  global_load_dwordx4 v[160:163], v[2:3], off
  s_mov_b64 exec, s[92:93]
  v_add_co_u32 v2, vcc, 0x1000, v2
  v_addc_co_u32 v3, vcc, 0, v3, vcc
  v_cmp_gt_i32 vcc, (k_code_end-k_pc-28672)/16, v0
  s_and_saveexec_b64 s[92:93], vcc
  s_cbranch_execz k_pf_done
  global_load_dwordx4 v[160:163], v[2:3], off
  s_mov_b64 exec, s[92:93]
  v_add_co_u32 v2, vcc, 0x1000, v2
  v_addc_co_u32 v3, vcc, 0, v3, vcc
k_pf_done:
  s_mov_b64 exec, -1
  s_and_b32 s52, s2, 7
  s_lshr_b32 s53, s2, 3
  s_mul_i32 s54, s52, 20
  s_add_u32 s40, s54, s53
  s_cmp_lt_u32 s2, 160
  s_cbranch_scc1 k_tb_done
  s_mul_i32 s54, s52, 12
  s_add_u32 s54, s54, s53
  s_add_u32 s40, s54, 140
k_tb_done:
  s_lshl_b32 s41, s40, 3
  v_lshrrev_b32 v2, 6, v0
  v_and_b32 v1, 63, v0
  s_nop 0
  v_readfirstlane_b32 s3, v2
  v_and_b32 v252, 7, v1
  v_lshrrev_b32 v5, 3, v1
  v_add_u32 v6, s41, v252
  s_movk_i32 s52, 1280
  v_mul_lo_u32 v6, v6, s52
  s_mul_i32 s53, s3, 320
  v_lshl_add_u32 v251, v5, 3, s53
  v_add_u32 v250, v6, v251
  s_waitcnt lgkmcnt(0)
  s_mov_b32 s8, s6
  s_mov_b32 s9, s7
  s_mov_b32 s10, 0x540000
  s_mov_b32 s11, 0x20000
  s_mov_b32 s12, s4
  s_mov_b32 s13, s5
  s_mov_b32 s14, 0x280000
  s_mov_b32 s15, 0x20000
  v_mov_b32 v199, 0
  s_mov_b32 s52, 5439488
  s_cmp_lg_u32 s2, 0
  s_cbranch_scc1 k_non0
  buffer_load_dword v197, v199, s[8:11], s52 offen sc1
k_non0:
  buffer_load_dwordx2 v[200:201], v250, s[12:15], 0 offen offset:0
  buffer_load_dwordx2 v[202:203], v250, s[12:15], 0 offen offset:64
  buffer_load_dwordx2 v[204:205], v250, s[12:15], 0 offen offset:128
  buffer_load_dwordx2 v[206:207], v250, s[12:15], 0 offen offset:192
  buffer_load_dwordx2 v[208:209], v250, s[12:15], 0 offen offset:256
  s_mov_b32 s20, s70
  s_mov_b32 s21, s71
  s_mov_b32 s22, 0x100
  s_mov_b32 s23, 0x20000
  s_mov_b32 s16, s60
  s_mov_b32 s17, s61
  s_mov_b32 s18, 0x500
  s_mov_b32 s19, 0x20000
  buffer_load_dwordx2 v[240:241], v251, s[16:19], 0 offen offset:0
  buffer_load_dwordx2 v[242:243], v251, s[16:19], 0 offen offset:64
  buffer_load_dwordx2 v[244:245], v251, s[16:19], 0 offen offset:128
  buffer_load_dwordx2 v[246:247], v251, s[16:19], 0 offen offset:192
  buffer_load_dwordx2 v[248:249], v251, s[16:19], 0 offen offset:256
  s_mov_b32 s12, s68
  s_mov_b32 s13, s69
  s_mov_b32 s14, 0x280000
  s_mov_b32 s15, 0x20000
  v_mov_b32 v40, -1
  v_mov_b32 v41, -1
  v_mov_b32 v42, -1
  v_mov_b32 v43, -1
  v_lshlrev_b32 v44, 4, v1
  s_cmp_ge_u32 s2, 160
  s_cbranch_scc1 k_p0_ffn
  s_mov_b32 s24, s44
  s_mov_b32 s25, s45
  s_mov_b32 s26, 0x3c000
  s_mov_b32 s27, 0x20000
  s_mov_b32 s28, s46
  s_mov_b32 s29, s47
  s_mov_b32 s30, 0x3c000
  s_mov_b32 s31, 0x20000
  s_mov_b32 s32, s48
  s_mov_b32 s33, s49
  s_mov_b32 s34, 0x3c000
  s_mov_b32 s35, 0x20000
  s_mov_b32 s36, s50
  s_mov_b32 s37, s51
  s_mov_b32 s38, 0x3c000
  s_mov_b32 s39, 0x20000
  s_lshl_b32 s74, s2, 2
  s_add_u32 s74, s74, s3
  s_mul_i32 s75, s3, 30432
  s_add_u32 s75, s75, 19712
  s_add_u32 s76, s75, 16640
  s_lshl_b32 s77, s74, 12
  s_add_u32 s77, s77, 2621440
  s_mul_i32 s52, s74, 384
  v_lshlrev_b32 v3, 1, v1
  s_and_b32 s53, s74, 0xfffffffe
  s_lshl_b32 s53, s53, 1
  s_load_dword s42, s[56:57], s53
  s_load_dword s79, s[58:59], s53
  buffer_load_ushort v100, v3, s[24:27], s52 offen offset:0
  buffer_load_ushort v101, v3, s[28:31], s52 offen offset:0
  buffer_load_ushort v102, v3, s[32:35], s52 offen offset:0
  buffer_load_ushort v103, v3, s[36:39], s52 offen offset:0
  buffer_load_ushort v104, v3, s[24:27], s52 offen offset:128
  buffer_load_ushort v105, v3, s[28:31], s52 offen offset:128
  buffer_load_ushort v106, v3, s[32:35], s52 offen offset:128
  buffer_load_ushort v107, v3, s[36:39], s52 offen offset:128
  buffer_load_ushort v108, v3, s[24:27], s52 offen offset:256
  buffer_load_ushort v109, v3, s[28:31], s52 offen offset:256
  buffer_load_ushort v110, v3, s[32:35], s52 offen offset:256
  buffer_load_ushort v111, v3, s[36:39], s52 offen offset:256
  v_lshlrev_b32 v8, 3, v1
  v_mov_b32 v112, 0
  v_mov_b32 v113, 0
  v_mov_b32 v114, 0
  v_mov_b32 v115, 0
  v_cmp_gt_u32 vcc, 48, v1
  s_and_saveexec_b64 s[54:55], vcc
  buffer_load_dwordx2 v[112:113], v8, s[32:35], s52 offen
  buffer_load_dwordx2 v[114:115], v8, s[36:39], s52 offen
  s_mov_b64 exec, s[54:55]
  s_waitcnt vmcnt(19)
  buffer_store_dwordx4 v[40:43], v44, s[8:11], s77 offen offset:0 sc1
  buffer_store_dwordx4 v[40:43], v44, s[8:11], s77 offen offset:1024 sc1
  buffer_store_dwordx4 v[40:43], v44, s[8:11], s77 offen offset:2048 sc1
  buffer_store_dwordx4 v[40:43], v44, s[8:11], s77 offen offset:3072 sc1
  s_branch k_p0_join
k_p0_ffn:
  s_sub_u32 s38, s2, 160
  s_waitcnt vmcnt(5)
k_p0_join:
  s_cmp_lg_u32 s2, 0
  s_cbranch_scc1 k_non1
  s_cmp_lg_u32 s3, 0
  s_cbranch_scc1 k_non1
  v_add_u32 v197, 1, v197
  v_max_u32 v197, 1, v197
  s_mov_b64 exec, 1
  buffer_store_dword v197, v199, s[20:23], 0 offen sc1
  s_mov_b64 exec, -1
k_non1:
  s_cmp_lg_u32 s3, 0
  s_cbranch_scc1 k_p0_j2
  s_mov_b64 exec, 0x3fffffff
  s_mul_i32 s52, s2, 480
  s_add_u32 s52, s52, 5308416
  buffer_store_dwordx4 v[40:43], v44, s[8:11], s52 offen sc1
  s_mov_b64 exec, 0xffff
  v_mov_b32 v46, 0
  v_mov_b32 v47, 0
  v_mov_b32 v48, 0
  v_mov_b32 v49, 0
  v_lshrrev_b32 v45, 1, v1
  v_lshlrev_b32 v45, 13, v45
  v_and_b32 v50, 1, v1
  v_lshl_add_u32 v45, v50, 4, v45
  s_lshl_b32 s52, s40, 5
  s_add_u32 s52, s52, 5242880
  buffer_store_dwordx4 v[46:49], v45, s[8:11], s52 offen sc1
  s_mov_b64 exec, -1
k_p0_j2:
  v_lshlrev_b32 v220, 16, v200
  v_and_b32 v221, 0xffff0000, v200
  v_lshlrev_b32 v222, 16, v201
  v_and_b32 v223, 0xffff0000, v201
  v_lshlrev_b32 v224, 16, v202
  v_and_b32 v225, 0xffff0000, v202
  v_lshlrev_b32 v226, 16, v203
  v_and_b32 v227, 0xffff0000, v203
  v_lshlrev_b32 v228, 16, v204
  v_and_b32 v229, 0xffff0000, v204
  v_lshlrev_b32 v230, 16, v205
  v_and_b32 v231, 0xffff0000, v205
  v_lshlrev_b32 v232, 16, v206
  v_and_b32 v233, 0xffff0000, v206
  v_lshlrev_b32 v234, 16, v207
  v_and_b32 v235, 0xffff0000, v207
  v_lshlrev_b32 v236, 16, v208
  v_and_b32 v237, 0xffff0000, v208
  v_lshlrev_b32 v238, 16, v209
  v_and_b32 v239, 0xffff0000, v209
  v_pk_add_f32 v[72:73], v[220:221], v[222:223]
  v_pk_add_f32 v[74:75], v[224:225], v[226:227]
  v_pk_add_f32 v[72:73], v[72:73], v[228:229]
  v_pk_add_f32 v[74:75], v[74:75], v[230:231]
  v_pk_add_f32 v[72:73], v[72:73], v[232:233]
  v_pk_add_f32 v[74:75], v[74:75], v[234:235]
  v_pk_add_f32 v[72:73], v[72:73], v[236:237]
  v_pk_add_f32 v[74:75], v[74:75], v[238:239]
  v_pk_add_f32 v[72:73], v[72:73], v[74:75]
  v_add_f32 v72, v72, v73
  s_nop 1
  v_add_f32_dpp v72, v72, v72 row_ror:8 row_mask:0xf bank_mask:0xf
  v_mov_b32 v73, v72
  s_nop 1
  v_permlane16_swap_b32 v72, v73
  s_nop 1
  v_add_f32 v72, v72, v73
  v_mov_b32 v73, v72
  s_nop 1
  v_permlane32_swap_b32 v72, v73
  s_nop 1
  v_add_f32 v72, v72, v73
  v_mul_f32 v72, 0x3bcccccd, v72
  v_pk_add_f32 v[70:71], v[220:221], v[72:73] op_sel_hi:[1,0] neg_lo:[0,1] neg_hi:[0,1]
  v_pk_mul_f32 v[74:75], v[70:71], v[70:71]
  v_pk_add_f32 v[76:77], v[222:223], v[72:73] op_sel_hi:[1,0] neg_lo:[0,1] neg_hi:[0,1]
  v_pk_mul_f32 v[82:83], v[76:77], v[76:77]
  v_pk_add_f32 v[70:71], v[224:225], v[72:73] op_sel_hi:[1,0] neg_lo:[0,1] neg_hi:[0,1]
  v_pk_fma_f32 v[74:75], v[70:71], v[70:71], v[74:75]
  v_pk_add_f32 v[76:77], v[226:227], v[72:73] op_sel_hi:[1,0] neg_lo:[0,1] neg_hi:[0,1]
  v_pk_fma_f32 v[82:83], v[76:77], v[76:77], v[82:83]
  v_pk_add_f32 v[70:71], v[228:229], v[72:73] op_sel_hi:[1,0] neg_lo:[0,1] neg_hi:[0,1]
  v_pk_fma_f32 v[74:75], v[70:71], v[70:71], v[74:75]
  v_pk_add_f32 v[76:77], v[230:231], v[72:73] op_sel_hi:[1,0] neg_lo:[0,1] neg_hi:[0,1]
  v_pk_fma_f32 v[82:83], v[76:77], v[76:77], v[82:83]
  v_pk_add_f32 v[70:71], v[232:233], v[72:73] op_sel_hi:[1,0] neg_lo:[0,1] neg_hi:[0,1]
  v_pk_fma_f32 v[74:75], v[70:71], v[70:71], v[74:75]
  v_pk_add_f32 v[76:77], v[234:235], v[72:73] op_sel_hi:[1,0] neg_lo:[0,1] neg_hi:[0,1]
  v_pk_fma_f32 v[82:83], v[76:77], v[76:77], v[82:83]
  v_pk_add_f32 v[70:71], v[236:237], v[72:73] op_sel_hi:[1,0] neg_lo:[0,1] neg_hi:[0,1]
  v_pk_fma_f32 v[74:75], v[70:71], v[70:71], v[74:75]
  v_pk_add_f32 v[76:77], v[238:239], v[72:73] op_sel_hi:[1,0] neg_lo:[0,1] neg_hi:[0,1]
  v_pk_fma_f32 v[82:83], v[76:77], v[76:77], v[82:83]
  v_pk_add_f32 v[74:75], v[74:75], v[82:83]
  v_add_f32 v73, v74, v75
  s_nop 1
  v_add_f32_dpp v73, v73, v73 row_ror:8 row_mask:0xf bank_mask:0xf
  v_mov_b32 v74, v73
  s_nop 1
  v_permlane16_swap_b32 v73, v74
  s_nop 1
  v_add_f32 v73, v73, v74
  v_mov_b32 v74, v73
  s_nop 1
  v_permlane32_swap_b32 v73, v74
  s_nop 1
  v_add_f32 v73, v73, v74
  v_lshlrev_b32 v76, 3, v252
  v_add_u32 v76, 10816, v76
  s_lshl_b32 s47, s3, 6
  v_add_u32 v77, s47, v76
  v_cmp_gt_u32 vcc, 8, v1
  s_and_saveexec_b64 s[48:49], vcc
  ds_write_b64 v77, v[72:73]
  s_mov_b64 exec, s[48:49]
  s_waitcnt lgkmcnt(0)
  s_barrier
  ds_read_b64 v[78:79], v76
  ds_read_b64 v[80:81], v76 offset:64
  ds_read_b64 v[82:83], v76 offset:128
  ds_read_b64 v[84:85], v76 offset:192
  s_waitcnt lgkmcnt(0)
  v_add_f32 v72, v78, v80
  v_add_f32 v73, v82, v84
  v_add_f32 v72, v72, v73
  v_mul_f32 v72, 0.25, v72
  v_sub_f32 v78, v78, v72
  v_sub_f32 v80, v80, v72
  v_sub_f32 v82, v82, v72
  v_sub_f32 v84, v84, v72
  v_mul_f32 v73, v78, v78
  v_fmac_f32 v73, v80, v80
  v_fmac_f32 v73, v82, v82
  v_fmac_f32 v73, v84, v84
  v_add_f32 v79, v79, v81
  v_add_f32 v83, v83, v85
  v_add_f32 v79, v79, v83
  v_fmac_f32 v79, 0x43200000, v73
  v_mul_f32 v74, 0x3acccccd, v79
  v_cvt_pk_bf16_f32 v78, 0, v72
  v_cvt_pk_bf16_f32 v75, 0, v74
  v_add_f32 v75, 0x3727c5ac, v75
  v_cvt_pk_bf16_f32 v75, 0, v75
  v_sqrt_f32 v75, v75
  s_nop 0
  v_cvt_pk_bf16_f32 v75, 0, v75
  v_rcp_f32 v80, v75
  s_nop 0
  v_pk_add_f32 v[86:87], v[220:221], v[78:79] op_sel_hi:[1,0] neg_lo:[0,1] neg_hi:[0,1]
  v_cvt_pk_bf16_f32 v86, 0, v86
  v_cvt_pk_bf16_f32 v87, 0, v87
  v_pk_mul_f32 v[86:87], v[86:87], v[80:81] op_sel_hi:[1,0]
  v_cvt_pk_bf16_f32 v86, 0, v86
  v_cvt_pk_bf16_f32 v87, 0, v87
  v_cvt_pk_f16_f32 v30, v86, v87
  v_pk_add_f32 v[88:89], v[222:223], v[78:79] op_sel_hi:[1,0] neg_lo:[0,1] neg_hi:[0,1]
  v_cvt_pk_bf16_f32 v88, 0, v88
  v_cvt_pk_bf16_f32 v89, 0, v89
  v_pk_mul_f32 v[88:89], v[88:89], v[80:81] op_sel_hi:[1,0]
  v_cvt_pk_bf16_f32 v88, 0, v88
  v_cvt_pk_bf16_f32 v89, 0, v89
  v_cvt_pk_f16_f32 v31, v88, v89
  v_pk_add_f32 v[86:87], v[224:225], v[78:79] op_sel_hi:[1,0] neg_lo:[0,1] neg_hi:[0,1]
  v_cvt_pk_bf16_f32 v86, 0, v86
  v_cvt_pk_bf16_f32 v87, 0, v87
  v_pk_mul_f32 v[86:87], v[86:87], v[80:81] op_sel_hi:[1,0]
  v_cvt_pk_bf16_f32 v86, 0, v86
  v_cvt_pk_bf16_f32 v87, 0, v87
  v_cvt_pk_f16_f32 v32, v86, v87
  v_pk_add_f32 v[88:89], v[226:227], v[78:79] op_sel_hi:[1,0] neg_lo:[0,1] neg_hi:[0,1]
  v_cvt_pk_bf16_f32 v88, 0, v88
  v_cvt_pk_bf16_f32 v89, 0, v89
  v_pk_mul_f32 v[88:89], v[88:89], v[80:81] op_sel_hi:[1,0]
  v_cvt_pk_bf16_f32 v88, 0, v88
  v_cvt_pk_bf16_f32 v89, 0, v89
  v_cvt_pk_f16_f32 v33, v88, v89
  v_pk_add_f32 v[86:87], v[228:229], v[78:79] op_sel_hi:[1,0] neg_lo:[0,1] neg_hi:[0,1]
  v_cvt_pk_bf16_f32 v86, 0, v86
  v_cvt_pk_bf16_f32 v87, 0, v87
  v_pk_mul_f32 v[86:87], v[86:87], v[80:81] op_sel_hi:[1,0]
  v_cvt_pk_bf16_f32 v86, 0, v86
  v_cvt_pk_bf16_f32 v87, 0, v87
  v_cvt_pk_f16_f32 v34, v86, v87
  v_pk_add_f32 v[88:89], v[230:231], v[78:79] op_sel_hi:[1,0] neg_lo:[0,1] neg_hi:[0,1]
  v_cvt_pk_bf16_f32 v88, 0, v88
  v_cvt_pk_bf16_f32 v89, 0, v89
  v_pk_mul_f32 v[88:89], v[88:89], v[80:81] op_sel_hi:[1,0]
  v_cvt_pk_bf16_f32 v88, 0, v88
  v_cvt_pk_bf16_f32 v89, 0, v89
  v_cvt_pk_f16_f32 v35, v88, v89
  v_pk_add_f32 v[86:87], v[232:233], v[78:79] op_sel_hi:[1,0] neg_lo:[0,1] neg_hi:[0,1]
  v_cvt_pk_bf16_f32 v86, 0, v86
  v_cvt_pk_bf16_f32 v87, 0, v87
  v_pk_mul_f32 v[86:87], v[86:87], v[80:81] op_sel_hi:[1,0]
  v_cvt_pk_bf16_f32 v86, 0, v86
  v_cvt_pk_bf16_f32 v87, 0, v87
  v_cvt_pk_f16_f32 v36, v86, v87
  v_pk_add_f32 v[88:89], v[234:235], v[78:79] op_sel_hi:[1,0] neg_lo:[0,1] neg_hi:[0,1]
  v_cvt_pk_bf16_f32 v88, 0, v88
  v_cvt_pk_bf16_f32 v89, 0, v89
  v_pk_mul_f32 v[88:89], v[88:89], v[80:81] op_sel_hi:[1,0]
  v_cvt_pk_bf16_f32 v88, 0, v88
  v_cvt_pk_bf16_f32 v89, 0, v89
  v_cvt_pk_f16_f32 v37, v88, v89
  v_pk_add_f32 v[86:87], v[236:237], v[78:79] op_sel_hi:[1,0] neg_lo:[0,1] neg_hi:[0,1]
  v_cvt_pk_bf16_f32 v86, 0, v86
  v_cvt_pk_bf16_f32 v87, 0, v87
  v_pk_mul_f32 v[86:87], v[86:87], v[80:81] op_sel_hi:[1,0]
  v_cvt_pk_bf16_f32 v86, 0, v86
  v_cvt_pk_bf16_f32 v87, 0, v87
  v_cvt_pk_f16_f32 v38, v86, v87
  v_pk_add_f32 v[88:89], v[238:239], v[78:79] op_sel_hi:[1,0] neg_lo:[0,1] neg_hi:[0,1]
  v_cvt_pk_bf16_f32 v88, 0, v88
  v_cvt_pk_bf16_f32 v89, 0, v89
  v_pk_mul_f32 v[88:89], v[88:89], v[80:81] op_sel_hi:[1,0]
  v_cvt_pk_bf16_f32 v88, 0, v88
  v_cvt_pk_bf16_f32 v89, 0, v89
  v_cvt_pk_f16_f32 v39, v88, v89
  s_movk_i32 s52, 1352
  v_mul_lo_u32 v6, v252, s52
  v_add_u32 v6, v6, v251
  ds_write_b64 v6, v[30:31] offset:0
  ds_write_b64 v6, v[32:33] offset:64
  ds_write_b64 v6, v[34:35] offset:128
  ds_write_b64 v6, v[36:37] offset:192
  ds_write_b64 v6, v[38:39] offset:256
  v_bfe_u32 v3, v1, 2, 2
  v_mul_lo_u32 v3, v3, s52
  v_lshrrev_b32 v4, 4, v1
  v_lshl_add_u32 v3, v4, 5, v3
  v_and_b32 v4, 3, v1
  v_lshl_add_u32 v3, v4, 3, v3
  s_lshl_b32 s53, s3, 7
  v_add_u32 v3, s53, v3
  v_lshlrev_b32 v4, 4, v0
  s_mul_i32 s52, s40, 10240
  s_add_u32 s52, s52, 0
  s_add_u32 s53, s52, 4096
  s_add_u32 s54, s52, 8192
  s_waitcnt lgkmcnt(0)
  s_barrier
  ds_read_b64_tr_b16 v[8:9], v3 offset:0
  ds_read_b64_tr_b16 v[10:11], v3 offset:5408
  ds_read_b64_tr_b16 v[12:13], v3 offset:512
  ds_read_b64_tr_b16 v[14:15], v3 offset:5920
  ds_read_b64_tr_b16 v[16:17], v3 offset:1024
  ds_read_b64_tr_b16 v[18:19], v3 offset:6432
  s_waitcnt lgkmcnt(0)
  buffer_store_dwordx4 v[8:11], v4, s[8:11], s52 offen sc1
  buffer_store_dwordx4 v[12:15], v4, s[8:11], s53 offen sc1
  s_cmp_ge_u32 s3, 2
  s_cbranch_scc1 k_ln1_skip
  buffer_store_dwordx4 v[16:19], v4, s[8:11], s54 offen sc1
k_ln1_skip:
  s_cmp_lg_u32 s3, 0
  s_cbranch_scc1 k_non2
  buffer_load_dword v198, v199, s[20:23], 0 offen sc1
k_non2:
  s_cmp_lt_u32 s2, 160
  s_cbranch_scc1 k_conv_role
  s_cmp_lg_u32 s3, 0
  s_cbranch_scc1 ff_w
  s_waitcnt vmcnt(0)
  v_cmp_eq_u32 vcc, 0, v198
  s_mov_b64 s[54:55], vcc
  s_cmp_eq_u64 vcc, 0
  s_cbranch_scc1 ff_have
  s_mov_b32 s53, 0
ffnon_1:
  s_mov_b64 exec, s[54:55]
  s_cbranch_execz ffnon_1_sk0
  buffer_load_dword v198, v199, s[20:23], 0 offen sc1
ffnon_1_sk0:
  s_mov_b64 exec, -1
  s_waitcnt vmcnt(0)
ffnon_1_chk:
  v_cmp_eq_u32 vcc, 0, v198
  s_and_b64 s[54:55], s[54:55], vcc
  s_cmp_eq_u64 s[54:55], 0
  s_cbranch_scc1 ffnon_1_done
  s_add_u32 s53, s53, 1
  s_sleep 1
  s_cmp_lt_u32 s53, 40000
  s_cbranch_scc1 ffnon_1
ffnon_1_done:
ff_have:
  v_mov_b32 v197, 11264
  ds_write_b32 v197, v198
  s_waitcnt lgkmcnt(0)
ff_w:
  s_waitcnt vmcnt(0)
  s_barrier
  s_cmp_lg_u32 s3, 0
  s_cbranch_scc1 ff_done
  v_lshlrev_b32 v197, 10, v1
  s_lshl_b32 s52, s2, 2
  s_add_u32 s52, s52, 5439488
  s_mov_b64 exec, 0xff
  buffer_store_dword v198, v197, s[8:11], s52 offen sc1
  s_mov_b64 exec, -1
ff_done:
  v_mov_b32 v197, 11264
  ds_read_b32 v199, v197
  s_waitcnt lgkmcnt(0)
  v_readfirstlane_b32 s72, v199
  s_branch k_ffn_pre
k_conv_role:
  s_waitcnt vmcnt(6)
  s_bitcmp1_b32 s74, 0
  s_cbranch_scc1 kg_odd
  s_lshl_b32 s42, s42, 16
  s_lshl_b32 s79, s79, 16
kg_odd:
  s_and_b32 s42, s42, 0xffff0000
  s_and_b32 s79, s79, 0xffff0000
  v_mov_b32 v14, 0x3fb8aa3b
  v_mul_f32 v15, s42, v14
  v_exp_f32 v15, v15
  s_mov_b32 s43, 0x7fff7fff
  v_and_b32 v112, s43, v112
  v_and_b32 v113, s43, v113
  v_and_b32 v114, s43, v114
  v_and_b32 v115, s43, v115
  v_cvt_pk_bf16_f32 v15, 0, v15
  v_pk_max_u16 v112, v112, v113
  v_pk_max_u16 v114, v114, v115
  v_pk_max_u16 v10, v112, v114
  v_lshrrev_b32 v11, 16, v10
  v_and_b32 v10, 0xffff, v10
  v_max_u32 v10, v10, v11
  s_nop 1
  v_max_u32_dpp v10, v10, v10 quad_perm:[1,0,3,2] row_mask:0xf bank_mask:0xf
  s_nop 1
  v_max_u32_dpp v10, v10, v10 quad_perm:[2,3,0,1] row_mask:0xf bank_mask:0xf
  s_nop 1
  v_max_u32_dpp v10, v10, v10 row_half_mirror row_mask:0xf bank_mask:0xf
  s_nop 1
  v_max_u32_dpp v10, v10, v10 row_mirror row_mask:0xf bank_mask:0xf
  v_mov_b32 v11, v10
  s_nop 1
  v_permlane16_swap_b32 v10, v11
  s_nop 1
  v_max_u32 v10, v10, v11
  v_mov_b32 v11, v10
  s_nop 1
  v_permlane32_swap_b32 v10, v11
  s_nop 1
  v_max_u32 v10, v10, v11
  v_lshlrev_b32 v10, 16, v10
  v_mul_f32 v10, v10, v15
  v_lshrrev_b32 v10, 23, v10
  v_max_u32 v10, 5, v10
  v_min_u32 v10, 0xfe, v10
  v_sub_u32 v11, 0x103, v10
  v_lshlrev_b32 v11, 23, v11
  v_subrev_u32 v30, 4, v10
  v_lshlrev_b32 v30, 23, v30
  v_mul_f32 v11, v11, v15
  v_lshrrev_b32 v13, 5, v1
  v_and_b32 v16, 31, v1
  v_mul_u32_u24 v16, 272, v16
  v_lshl_add_u32 v13, v13, 4, v16
  v_add_u32 v13, s75, v13
  v_lshlrev_b32 v100, 16, v100
  v_lshlrev_b32 v101, 16, v101
  v_mul_f32 v4, v14, v100
  v_exp_f32 v4, v4
  v_mul_f32 v5, v101, v15
  v_mul_f32 v5, 0x3e22f983, v5
  v_cvt_pk_bf16_f32 v4, 0, v4
  v_mul_f32 v4, v4, v15
  v_mul_f32 v4, v4, v14
  v_exp_f32 v6, -v4
  v_fract_f32 v7, v5
  v_cos_f32 v18, v7
  v_sin_f32 v19, v7
  s_nop 0
  v_mul_f32 v18, v18, v6
  v_mul_f32 v19, v19, v6
  v_mul_f32 v8, 0x41000000, v4
  v_mul_f32 v9, 0x41000000, v5
  v_exp_f32 v8, -v8
  v_fract_f32 v9, v9
  v_cos_f32 v20, v9
  v_sin_f32 v21, v9
  s_nop 0
  v_mul_f32 v20, v20, v8
  v_mul_f32 v21, v21, v8
  v_mul_f32 v6, 0x43800000, v4
  v_mul_f32 v7, 0x43800000, v5
  v_exp_f32 v6, -v6
  v_fract_f32 v7, v7
  v_cos_f32 v22, v7
  v_sin_f32 v23, v7
  s_nop 0
  v_mul_f32 v22, v22, v6
  v_mul_f32 v23, v23, v6
  v_lshlrev_b32 v102, 16, v102
  v_lshlrev_b32 v103, 16, v103
  v_mul_f32 v44, v102, v11
  v_mul_f32 v45, v103, v11
  s_mov_b32 m0, s75
  s_nop 0
  v_mov_b32 v46, 0x3c00
  v_cvt_pk_f16_f32 v120, v44, -v45
  v_pk_mul_f32 v[118:119], v[44:45], v[20:21] op_sel:[0,0] op_sel_hi:[1,0]
  v_cvt_pk_f16_f32 v47, v18, v19
  v_pk_fma_f32 v[116:117], v[44:45], v[20:21], v[118:119] op_sel:[1,1,0] op_sel_hi:[0,1,1] neg_lo:[1,0,0]
  v_cvt_pk_f16_f32 v121, v116, -v117
  ds_write_addtid_b32 v46 offset:0
  ds_write_addtid_b32 v120 offset:5712
  v_pk_mul_f32 v[42:43], v[18:19], v[18:19] op_sel:[0,0] op_sel_hi:[1,0]
  v_pk_mul_f32 v[118:119], v[116:117], v[20:21] op_sel:[0,0] op_sel_hi:[1,0]
  v_pk_fma_f32 v[116:117], v[116:117], v[20:21], v[118:119] op_sel:[1,1,0] op_sel_hi:[0,1,1] neg_lo:[1,0,0]
  v_pk_fma_f32 v[24:25], v[18:19], v[18:19], v[42:43] op_sel:[1,1,0] op_sel_hi:[0,1,1] neg_lo:[1,0,0]
  v_cvt_pk_f16_f32 v124, v116, -v117
  ds_write_addtid_b32 v121 offset:5984
  v_cvt_pk_f16_f32 v122, v24, v25
  v_pk_mul_f32 v[118:119], v[116:117], v[20:21] op_sel:[0,0] op_sel_hi:[1,0]
  ds_write_addtid_b32 v47 offset:272
  v_pk_fma_f32 v[116:117], v[116:117], v[20:21], v[118:119] op_sel:[1,1,0] op_sel_hi:[0,1,1] neg_lo:[1,0,0]
  v_cvt_pk_f16_f32 v125, v116, -v117
  v_cvt_pk_f16_f32 v123, v22, v23
  ds_write_addtid_b32 v124 offset:6256
  ds_write_addtid_b32 v122 offset:544
  v_pk_mul_f32 v[118:119], v[116:117], v[20:21] op_sel:[0,0] op_sel_hi:[1,0]
  v_pk_fma_f32 v[116:117], v[116:117], v[20:21], v[118:119] op_sel:[1,1,0] op_sel_hi:[0,1,1] neg_lo:[1,0,0]
  v_pk_mul_f32 v[42:43], v[22:23], v[22:23] op_sel:[0,0] op_sel_hi:[1,0]
  v_cvt_pk_f16_f32 v120, v116, -v117
  ds_write_addtid_b32 v125 offset:6528
  v_pk_fma_f32 v[34:35], v[22:23], v[22:23], v[42:43] op_sel:[1,1,0] op_sel_hi:[0,1,1] neg_lo:[1,0,0]
  v_pk_mul_f32 v[118:119], v[116:117], v[20:21] op_sel:[0,0] op_sel_hi:[1,0]
  v_cvt_pk_f16_f32 v46, v34, v35
  v_pk_fma_f32 v[116:117], v[116:117], v[20:21], v[118:119] op_sel:[1,1,0] op_sel_hi:[0,1,1] neg_lo:[1,0,0]
  v_cvt_pk_f16_f32 v121, v116, -v117
  ds_write_addtid_b32 v123 offset:2176
  ds_write_addtid_b32 v120 offset:6800
  v_pk_mul_f32 v[42:43], v[24:25], v[18:19] op_sel:[0,0] op_sel_hi:[1,0]
  v_pk_mul_f32 v[118:119], v[116:117], v[20:21] op_sel:[0,0] op_sel_hi:[1,0]
  v_pk_fma_f32 v[116:117], v[116:117], v[20:21], v[118:119] op_sel:[1,1,0] op_sel_hi:[0,1,1] neg_lo:[1,0,0]
  v_pk_fma_f32 v[26:27], v[24:25], v[18:19], v[42:43] op_sel:[1,1,0] op_sel_hi:[0,1,1] neg_lo:[1,0,0]
  v_cvt_pk_f16_f32 v124, v116, -v117
  ds_write_addtid_b32 v121 offset:7072
  v_cvt_pk_f16_f32 v47, v26, v27
  v_pk_mul_f32 v[118:119], v[116:117], v[20:21] op_sel:[0,0] op_sel_hi:[1,0]
  ds_write_addtid_b32 v46 offset:3264
  v_pk_fma_f32 v[116:117], v[116:117], v[20:21], v[118:119] op_sel:[1,1,0] op_sel_hi:[0,1,1] neg_lo:[1,0,0]
  v_cvt_pk_f16_f32 v125, v116, -v117
  v_pk_mul_f32 v[42:43], v[24:25], v[24:25] op_sel:[0,0] op_sel_hi:[1,0]
  ds_write_addtid_b32 v124 offset:7344
  v_pk_mul_f32 v[118:119], v[116:117], v[20:21] op_sel:[0,0] op_sel_hi:[1,0]
  v_pk_fma_f32 v[28:29], v[24:25], v[24:25], v[42:43] op_sel:[1,1,0] op_sel_hi:[0,1,1] neg_lo:[1,0,0]
  v_pk_fma_f32 v[116:117], v[116:117], v[20:21], v[118:119] op_sel:[1,1,0] op_sel_hi:[0,1,1] neg_lo:[1,0,0]
  v_cvt_pk_f16_f32 v122, v28, v29
  v_cvt_pk_f16_f32 v120, v116, -v117
  ds_write_addtid_b32 v125 offset:7616
  ds_write_addtid_b32 v47 offset:816
  v_pk_mul_f32 v[118:119], v[116:117], v[20:21] op_sel:[0,0] op_sel_hi:[1,0]
  v_pk_mul_f32 v[42:43], v[34:35], v[22:23] op_sel:[0,0] op_sel_hi:[1,0]
  v_pk_fma_f32 v[116:117], v[116:117], v[20:21], v[118:119] op_sel:[1,1,0] op_sel_hi:[0,1,1] neg_lo:[1,0,0]
  v_cvt_pk_f16_f32 v121, v116, -v117
  v_pk_fma_f32 v[36:37], v[34:35], v[22:23], v[42:43] op_sel:[1,1,0] op_sel_hi:[0,1,1] neg_lo:[1,0,0]
  ds_write_addtid_b32 v120 offset:7888
  v_pk_mul_f32 v[118:119], v[116:117], v[20:21] op_sel:[0,0] op_sel_hi:[1,0]
  v_cvt_pk_f16_f32 v123, v36, v37
  v_pk_fma_f32 v[116:117], v[116:117], v[20:21], v[118:119] op_sel:[1,1,0] op_sel_hi:[0,1,1] neg_lo:[1,0,0]
  ds_write_addtid_b32 v122 offset:1088
  v_cvt_pk_f16_f32 v124, v116, -v117
  ds_write_addtid_b32 v121 offset:8160
  v_pk_mul_f32 v[42:43], v[28:29], v[18:19] op_sel:[0,0] op_sel_hi:[1,0]
  v_pk_mul_f32 v[118:119], v[116:117], v[20:21] op_sel:[0,0] op_sel_hi:[1,0]
  v_pk_fma_f32 v[40:41], v[28:29], v[18:19], v[42:43] op_sel:[1,1,0] op_sel_hi:[0,1,1] neg_lo:[1,0,0]
  v_pk_fma_f32 v[116:117], v[116:117], v[20:21], v[118:119] op_sel:[1,1,0] op_sel_hi:[0,1,1] neg_lo:[1,0,0]
  v_cvt_pk_f16_f32 v125, v116, -v117
  v_cvt_pk_f16_f32 v46, v40, v41
  ds_write_addtid_b32 v124 offset:8432
  v_pk_mul_f32 v[118:119], v[116:117], v[20:21] op_sel:[0,0] op_sel_hi:[1,0]
  ds_write_addtid_b32 v123 offset:3808
  v_pk_fma_f32 v[116:117], v[116:117], v[20:21], v[118:119] op_sel:[1,1,0] op_sel_hi:[0,1,1] neg_lo:[1,0,0]
  v_pk_mul_f32 v[42:43], v[28:29], v[24:25] op_sel:[0,0] op_sel_hi:[1,0]
  v_cvt_pk_f16_f32 v120, v116, -v117
  ds_write_addtid_b32 v125 offset:8704
  v_pk_fma_f32 v[32:33], v[28:29], v[24:25], v[42:43] op_sel:[1,1,0] op_sel_hi:[0,1,1] neg_lo:[1,0,0]
  v_pk_mul_f32 v[118:119], v[116:117], v[20:21] op_sel:[0,0] op_sel_hi:[1,0]
  v_pk_fma_f32 v[116:117], v[116:117], v[20:21], v[118:119] op_sel:[1,1,0] op_sel_hi:[0,1,1] neg_lo:[1,0,0]
  v_cvt_pk_f16_f32 v47, v32, v33
  v_cvt_pk_f16_f32 v121, v116, -v117
  ds_write_addtid_b32 v46 offset:1360
  ds_write_addtid_b32 v120 offset:8976
  v_pk_mul_f32 v[118:119], v[116:117], v[20:21] op_sel:[0,0] op_sel_hi:[1,0]
  v_pk_mul_f32 v[42:43], v[28:29], v[26:27] op_sel:[0,0] op_sel_hi:[1,0]
  v_pk_fma_f32 v[116:117], v[116:117], v[20:21], v[118:119] op_sel:[1,1,0] op_sel_hi:[0,1,1] neg_lo:[1,0,0]
  v_pk_fma_f32 v[40:41], v[28:29], v[26:27], v[42:43] op_sel:[1,1,0] op_sel_hi:[0,1,1] neg_lo:[1,0,0]
  v_cvt_pk_f16_f32 v124, v116, -v117
  ds_write_addtid_b32 v121 offset:9248
  v_cvt_pk_f16_f32 v122, v40, v41
  v_pk_mul_f32 v[118:119], v[116:117], v[20:21] op_sel:[0,0] op_sel_hi:[1,0]
  v_pk_fma_f32 v[116:117], v[116:117], v[20:21], v[118:119] op_sel:[1,1,0] op_sel_hi:[0,1,1] neg_lo:[1,0,0]
  ds_write_addtid_b32 v47 offset:1632
  v_cvt_pk_f16_f32 v125, v116, -v117
  v_pk_mul_f32 v[42:43], v[22:23], v[24:25] op_sel:[0,0] op_sel_hi:[1,0]
  ds_write_addtid_b32 v124 offset:9520
  v_pk_mul_f32 v[118:119], v[116:117], v[20:21] op_sel:[0,0] op_sel_hi:[1,0]
  v_pk_fma_f32 v[40:41], v[22:23], v[24:25], v[42:43] op_sel:[1,1,0] op_sel_hi:[0,1,1] neg_lo:[1,0,0]
  v_pk_fma_f32 v[116:117], v[116:117], v[20:21], v[118:119] op_sel:[1,1,0] op_sel_hi:[0,1,1] neg_lo:[1,0,0]
  v_cvt_pk_f16_f32 v123, v40, v41
  v_cvt_pk_f16_f32 v120, v116, -v117
  ds_write_addtid_b32 v125 offset:9792
  ds_write_addtid_b32 v122 offset:1904
  v_pk_mul_f32 v[118:119], v[116:117], v[20:21] op_sel:[0,0] op_sel_hi:[1,0]
  v_pk_fma_f32 v[116:117], v[116:117], v[20:21], v[118:119] op_sel:[1,1,0] op_sel_hi:[0,1,1] neg_lo:[1,0,0]
  v_pk_mul_f32 v[42:43], v[22:23], v[28:29] op_sel:[0,0] op_sel_hi:[1,0]
  v_cvt_pk_f16_f32 v121, v116, -v117
  v_pk_fma_f32 v[40:41], v[22:23], v[28:29], v[42:43] op_sel:[1,1,0] op_sel_hi:[0,1,1] neg_lo:[1,0,0]
  ds_write_addtid_b32 v120 offset:10064
  v_pk_mul_f32 v[118:119], v[116:117], v[20:21] op_sel:[0,0] op_sel_hi:[1,0]
  v_cvt_pk_f16_f32 v46, v40, v41
  v_pk_fma_f32 v[116:117], v[116:117], v[20:21], v[118:119] op_sel:[1,1,0] op_sel_hi:[0,1,1] neg_lo:[1,0,0]
  v_cvt_pk_f16_f32 v124, v116, -v117
  ds_write_addtid_b32 v123 offset:2448
  ds_write_addtid_b32 v121 offset:10336
  v_pk_mul_f32 v[42:43], v[22:23], v[32:33] op_sel:[0,0] op_sel_hi:[1,0]
  v_pk_mul_f32 v[118:119], v[116:117], v[20:21] op_sel:[0,0] op_sel_hi:[1,0]
  v_pk_fma_f32 v[116:117], v[116:117], v[20:21], v[118:119] op_sel:[1,1,0] op_sel_hi:[0,1,1] neg_lo:[1,0,0]
  v_pk_fma_f32 v[40:41], v[22:23], v[32:33], v[42:43] op_sel:[1,1,0] op_sel_hi:[0,1,1] neg_lo:[1,0,0]
  v_cvt_pk_f16_f32 v125, v116, -v117
  v_cvt_pk_f16_f32 v47, v40, v41
  ds_write_addtid_b32 v124 offset:10608
  v_pk_mul_f32 v[118:119], v[116:117], v[20:21] op_sel:[0,0] op_sel_hi:[1,0]
  ds_write_addtid_b32 v46 offset:2720
  v_pk_fma_f32 v[116:117], v[116:117], v[20:21], v[118:119] op_sel:[1,1,0] op_sel_hi:[0,1,1] neg_lo:[1,0,0]
  v_cvt_pk_f16_f32 v120, v116, -v117
  v_pk_mul_f32 v[42:43], v[34:35], v[28:29] op_sel:[0,0] op_sel_hi:[1,0]
  ds_write_addtid_b32 v125 offset:10880
  v_pk_fma_f32 v[40:41], v[34:35], v[28:29], v[42:43] op_sel:[1,1,0] op_sel_hi:[0,1,1] neg_lo:[1,0,0]
  v_pk_mul_f32 v[118:119], v[116:117], v[20:21] op_sel:[0,0] op_sel_hi:[1,0]
  v_pk_fma_f32 v[116:117], v[116:117], v[20:21], v[118:119] op_sel:[1,1,0] op_sel_hi:[0,1,1] neg_lo:[1,0,0]
  v_cvt_pk_f16_f32 v122, v40, v41
  v_cvt_pk_f16_f32 v121, v116, -v117
  ds_write_addtid_b32 v47 offset:2992
  ds_write_addtid_b32 v120 offset:11152
  v_pk_mul_f32 v[118:119], v[116:117], v[20:21] op_sel:[0,0] op_sel_hi:[1,0]
  v_pk_mul_f32 v[42:43], v[36:37], v[28:29] op_sel:[0,0] op_sel_hi:[1,0]
  v_pk_fma_f32 v[116:117], v[116:117], v[20:21], v[118:119] op_sel:[1,1,0] op_sel_hi:[0,1,1] neg_lo:[1,0,0]
  v_cvt_pk_f16_f32 v124, v116, -v117
  v_pk_fma_f32 v[40:41], v[36:37], v[28:29], v[42:43] op_sel:[1,1,0] op_sel_hi:[0,1,1] neg_lo:[1,0,0]
  ds_write_addtid_b32 v121 offset:11424
  v_cvt_pk_f16_f32 v123, v40, v41
  v_pk_mul_f32 v[118:119], v[116:117], v[20:21] op_sel:[0,0] op_sel_hi:[1,0]
  v_pk_fma_f32 v[116:117], v[116:117], v[20:21], v[118:119] op_sel:[1,1,0] op_sel_hi:[0,1,1] neg_lo:[1,0,0]
  ds_write_addtid_b32 v122 offset:3536
  v_cvt_pk_f16_f32 v125, v116, -v117
  ds_write_addtid_b32 v124 offset:11696
  v_pk_mul_f32 v[42:43], v[34:35], v[34:35] op_sel:[0,0] op_sel_hi:[1,0]
  v_pk_mul_f32 v[118:119], v[116:117], v[20:21] op_sel:[0,0] op_sel_hi:[1,0]
  v_pk_fma_f32 v[36:37], v[34:35], v[34:35], v[42:43] op_sel:[1,1,0] op_sel_hi:[0,1,1] neg_lo:[1,0,0]
  v_pk_fma_f32 v[116:117], v[116:117], v[20:21], v[118:119] op_sel:[1,1,0] op_sel_hi:[0,1,1] neg_lo:[1,0,0]
  v_cvt_pk_f16_f32 v120, v116, -v117
  v_cvt_pk_f16_f32 v46, v36, v37
  ds_write_addtid_b32 v125 offset:11968
  ds_write_addtid_b32 v123 offset:4080
  v_pk_mul_f32 v[118:119], v[116:117], v[20:21] op_sel:[0,0] op_sel_hi:[1,0]
  v_pk_fma_f32 v[116:117], v[116:117], v[20:21], v[118:119] op_sel:[1,1,0] op_sel_hi:[0,1,1] neg_lo:[1,0,0]
  v_pk_mul_f32 v[42:43], v[36:37], v[22:23] op_sel:[0,0] op_sel_hi:[1,0]
  v_cvt_pk_f16_f32 v121, v116, -v117
  ds_write_addtid_b32 v120 offset:12240
  v_pk_fma_f32 v[40:41], v[36:37], v[22:23], v[42:43] op_sel:[1,1,0] op_sel_hi:[0,1,1] neg_lo:[1,0,0]
  v_pk_mul_f32 v[118:119], v[116:117], v[20:21] op_sel:[0,0] op_sel_hi:[1,0]
  v_cvt_pk_f16_f32 v47, v40, v41
  v_pk_fma_f32 v[116:117], v[116:117], v[20:21], v[118:119] op_sel:[1,1,0] op_sel_hi:[0,1,1] neg_lo:[1,0,0]
  v_cvt_pk_f16_f32 v124, v116, -v117
  ds_write_addtid_b32 v46 offset:4352
  ds_write_addtid_b32 v121 offset:12512
  v_pk_mul_f32 v[42:43], v[36:37], v[34:35] op_sel:[0,0] op_sel_hi:[1,0]
  v_pk_mul_f32 v[118:119], v[116:117], v[20:21] op_sel:[0,0] op_sel_hi:[1,0]
  v_pk_fma_f32 v[116:117], v[116:117], v[20:21], v[118:119] op_sel:[1,1,0] op_sel_hi:[0,1,1] neg_lo:[1,0,0]
  v_pk_fma_f32 v[38:39], v[36:37], v[34:35], v[42:43] op_sel:[1,1,0] op_sel_hi:[0,1,1] neg_lo:[1,0,0]
  v_cvt_pk_f16_f32 v125, v116, -v117
  ds_write_addtid_b32 v124 offset:12784
  v_cvt_pk_f16_f32 v122, v38, v39
  v_pk_mul_f32 v[118:119], v[116:117], v[20:21] op_sel:[0,0] op_sel_hi:[1,0]
  ds_write_addtid_b32 v47 offset:4624
  v_pk_fma_f32 v[116:117], v[116:117], v[20:21], v[118:119] op_sel:[1,1,0] op_sel_hi:[0,1,1] neg_lo:[1,0,0]
  v_cvt_pk_f16_f32 v120, v116, -v117
  v_pk_mul_f32 v[42:43], v[38:39], v[22:23] op_sel:[0,0] op_sel_hi:[1,0]
  ds_write_addtid_b32 v125 offset:13056
  v_pk_mul_f32 v[118:119], v[116:117], v[20:21] op_sel:[0,0] op_sel_hi:[1,0]
  v_pk_fma_f32 v[40:41], v[38:39], v[22:23], v[42:43] op_sel:[1,1,0] op_sel_hi:[0,1,1] neg_lo:[1,0,0]
  v_pk_fma_f32 v[116:117], v[116:117], v[20:21], v[118:119] op_sel:[1,1,0] op_sel_hi:[0,1,1] neg_lo:[1,0,0]
  v_cvt_pk_f16_f32 v123, v40, v41
  v_cvt_pk_f16_f32 v121, v116, -v117
  ds_write_addtid_b32 v120 offset:13328
  ds_write_addtid_b32 v122 offset:4896
  v_pk_mul_f32 v[118:119], v[116:117], v[20:21] op_sel:[0,0] op_sel_hi:[1,0]
  v_pk_mul_f32 v[42:43], v[36:37], v[36:37] op_sel:[0,0] op_sel_hi:[1,0]
  v_pk_fma_f32 v[116:117], v[116:117], v[20:21], v[118:119] op_sel:[1,1,0] op_sel_hi:[0,1,1] neg_lo:[1,0,0]
  v_cvt_pk_f16_f32 v124, v116, -v117
  v_pk_fma_f32 v[40:41], v[36:37], v[36:37], v[42:43] op_sel:[1,1,0] op_sel_hi:[0,1,1] neg_lo:[1,0,0]
  ds_write_addtid_b32 v121 offset:13600
  v_pk_mul_f32 v[118:119], v[116:117], v[20:21] op_sel:[0,0] op_sel_hi:[1,0]
  v_cvt_pk_f16_f32 v46, v40, v41
  v_pk_fma_f32 v[116:117], v[116:117], v[20:21], v[118:119] op_sel:[1,1,0] op_sel_hi:[0,1,1] neg_lo:[1,0,0]
  ds_write_addtid_b32 v123 offset:5168
  v_cvt_pk_f16_f32 v125, v116, -v117
  ds_write_addtid_b32 v124 offset:13872
  ds_write_addtid_b32 v46 offset:5440
  ds_write_addtid_b32 v125 offset:14144
  s_cmp_lg_u32 s3, 0
  s_cbranch_scc1 cf_w
  s_waitcnt vmcnt(0)
  v_cmp_eq_u32 vcc, 0, v198
  s_mov_b64 s[54:55], vcc
  s_cmp_eq_u64 vcc, 0
  s_cbranch_scc1 cf_have
  s_mov_b32 s53, 0
cfnon_2:
  s_mov_b64 exec, s[54:55]
  s_cbranch_execz cfnon_2_sk0
  buffer_load_dword v198, v199, s[20:23], 0 offen sc1
cfnon_2_sk0:
  s_mov_b64 exec, -1
  s_waitcnt vmcnt(0)
cfnon_2_chk:
  v_cmp_eq_u32 vcc, 0, v198
  s_and_b64 s[54:55], s[54:55], vcc
  s_cmp_eq_u64 s[54:55], 0
  s_cbranch_scc1 cfnon_2_done
  s_add_u32 s53, s53, 1
  s_sleep 1
  s_cmp_lt_u32 s53, 40000
  s_cbranch_scc1 cfnon_2
cfnon_2_done:
cf_have:
  v_mov_b32 v197, 11264
  ds_write_b32 v197, v198
  s_waitcnt lgkmcnt(0)
cf_w:
  s_waitcnt vmcnt(0)
  s_barrier
  s_cmp_lg_u32 s3, 0
  s_cbranch_scc1 cf_done
  v_lshlrev_b32 v197, 10, v1
  s_lshl_b32 s52, s2, 2
  s_add_u32 s52, s52, 5439488
  s_mov_b64 exec, 0xff
  buffer_store_dword v198, v197, s[8:11], s52 offen sc1
  s_mov_b64 exec, -1
cf_done:
  v_mov_b32 v197, 11264
  ds_read_b32 v199, v197
  s_add_u32 s43, s75, 0
  ds_read_b128 v[128:131], v13 offset:0
  ds_read_b128 v[132:135], v13 offset:5712
  ds_read_b128 v[136:139], v13 offset:32
  ds_read_b128 v[140:143], v13 offset:5744
  ds_read_b128 v[144:147], v13 offset:64
  ds_read_b128 v[148:151], v13 offset:5776
  ds_read_b128 v[152:155], v13 offset:96
  ds_read_b128 v[156:159], v13 offset:5808
  ds_read_b128 v[160:163], v13 offset:128
  ds_read_b128 v[164:167], v13 offset:5840
  ds_read_b128 v[168:171], v13 offset:160
  ds_read_b128 v[172:175], v13 offset:5872
  ds_read_b128 v[176:179], v13 offset:192
  ds_read_b128 v[180:183], v13 offset:5904
  ds_read_b128 v[184:187], v13 offset:224
  ds_read_b128 v[188:191], v13 offset:5936
  s_add_u32 s43, s75, 14416
  s_mov_b32 m0, s43
  v_lshlrev_b32 v104, 16, v104
  v_lshlrev_b32 v105, 16, v105
  v_mul_f32 v4, v14, v104
  v_exp_f32 v4, v4
  v_mul_f32 v5, v105, v15
  v_mul_f32 v5, 0x3e22f983, v5
  v_cvt_pk_bf16_f32 v4, 0, v4
  v_mul_f32 v4, v4, v15
  v_mul_f32 v4, v4, v14
  v_exp_f32 v6, -v4
  v_fract_f32 v7, v5
  v_cos_f32 v18, v7
  v_sin_f32 v19, v7
  s_nop 0
  v_mul_f32 v18, v18, v6
  v_mul_f32 v19, v19, v6
  v_mul_f32 v8, 0x41000000, v4
  v_mul_f32 v9, 0x41000000, v5
  v_exp_f32 v8, -v8
  v_fract_f32 v9, v9
  v_cos_f32 v20, v9
  v_sin_f32 v21, v9
  s_nop 0
  v_mul_f32 v20, v20, v8
  v_mul_f32 v21, v21, v8
  v_mul_f32 v6, 0x43800000, v4
  v_mul_f32 v7, 0x43800000, v5
  v_exp_f32 v6, -v6
  v_fract_f32 v7, v7
  v_cos_f32 v22, v7
  s_waitcnt lgkmcnt(14)
  v_mfma_f32_32x32x16_f16 v[48:63], v[128:131], v[132:135], 0
  v_sin_f32 v23, v7
  s_nop 0
  v_mul_f32 v22, v22, v6
  v_mul_f32 v23, v23, v6
  v_lshlrev_b32 v106, 16, v106
  v_lshlrev_b32 v107, 16, v107
  v_mul_f32 v44, v106, v11
  v_mul_f32 v45, v107, v11
  v_mov_b32 v46, 0x3c00
  v_cvt_pk_f16_f32 v120, v44, -v45
  v_pk_mul_f32 v[118:119], v[44:45], v[20:21] op_sel:[0,0] op_sel_hi:[1,0]
  v_cvt_pk_f16_f32 v47, v18, v19
  v_pk_fma_f32 v[116:117], v[44:45], v[20:21], v[118:119] op_sel:[1,1,0] op_sel_hi:[0,1,1] neg_lo:[1,0,0]
  v_cvt_pk_f16_f32 v121, v116, -v117
  ds_write_addtid_b32 v46 offset:0
  ds_write_addtid_b32 v120 offset:5712
  v_pk_mul_f32 v[42:43], v[18:19], v[18:19] op_sel:[0,0] op_sel_hi:[1,0]
  v_pk_mul_f32 v[118:119], v[116:117], v[20:21] op_sel:[0,0] op_sel_hi:[1,0]
  v_pk_fma_f32 v[116:117], v[116:117], v[20:21], v[118:119] op_sel:[1,1,0] op_sel_hi:[0,1,1] neg_lo:[1,0,0]
  v_pk_fma_f32 v[24:25], v[18:19], v[18:19], v[42:43] op_sel:[1,1,0] op_sel_hi:[0,1,1] neg_lo:[1,0,0]
  v_cvt_pk_f16_f32 v124, v116, -v117
  ds_write_addtid_b32 v121 offset:5984
  v_cvt_pk_f16_f32 v122, v24, v25
  v_pk_mul_f32 v[118:119], v[116:117], v[20:21] op_sel:[0,0] op_sel_hi:[1,0]
  ds_write_addtid_b32 v47 offset:272
  v_pk_fma_f32 v[116:117], v[116:117], v[20:21], v[118:119] op_sel:[1,1,0] op_sel_hi:[0,1,1] neg_lo:[1,0,0]
  v_cvt_pk_f16_f32 v125, v116, -v117
  s_waitcnt lgkmcnt(15)
  v_mfma_f32_32x32x16_f16 v[48:63], v[136:139], v[140:143], v[48:63]
  v_cvt_pk_f16_f32 v123, v22, v23
  ds_write_addtid_b32 v124 offset:6256
  ds_write_addtid_b32 v122 offset:544
  v_pk_mul_f32 v[118:119], v[116:117], v[20:21] op_sel:[0,0] op_sel_hi:[1,0]
  v_pk_fma_f32 v[116:117], v[116:117], v[20:21], v[118:119] op_sel:[1,1,0] op_sel_hi:[0,1,1] neg_lo:[1,0,0]
  v_pk_mul_f32 v[42:43], v[22:23], v[22:23] op_sel:[0,0] op_sel_hi:[1,0]
  v_cvt_pk_f16_f32 v120, v116, -v117
  ds_write_addtid_b32 v125 offset:6528
  v_pk_fma_f32 v[34:35], v[22:23], v[22:23], v[42:43] op_sel:[1,1,0] op_sel_hi:[0,1,1] neg_lo:[1,0,0]
  v_pk_mul_f32 v[118:119], v[116:117], v[20:21] op_sel:[0,0] op_sel_hi:[1,0]
  v_cvt_pk_f16_f32 v46, v34, v35
  v_pk_fma_f32 v[116:117], v[116:117], v[20:21], v[118:119] op_sel:[1,1,0] op_sel_hi:[0,1,1] neg_lo:[1,0,0]
  v_cvt_pk_f16_f32 v121, v116, -v117
  ds_write_addtid_b32 v123 offset:2176
  ds_write_addtid_b32 v120 offset:6800
  v_pk_mul_f32 v[42:43], v[24:25], v[18:19] op_sel:[0,0] op_sel_hi:[1,0]
  v_pk_mul_f32 v[118:119], v[116:117], v[20:21] op_sel:[0,0] op_sel_hi:[1,0]
  v_pk_fma_f32 v[116:117], v[116:117], v[20:21], v[118:119] op_sel:[1,1,0] op_sel_hi:[0,1,1] neg_lo:[1,0,0]
  v_pk_fma_f32 v[26:27], v[24:25], v[18:19], v[42:43] op_sel:[1,1,0] op_sel_hi:[0,1,1] neg_lo:[1,0,0]
  v_cvt_pk_f16_f32 v124, v116, -v117
  ds_write_addtid_b32 v121 offset:7072
  v_cvt_pk_f16_f32 v47, v26, v27
  v_pk_mul_f32 v[118:119], v[116:117], v[20:21] op_sel:[0,0] op_sel_hi:[1,0]
  ds_write_addtid_b32 v46 offset:3264
  v_pk_fma_f32 v[116:117], v[116:117], v[20:21], v[118:119] op_sel:[1,1,0] op_sel_hi:[0,1,1] neg_lo:[1,0,0]
  v_cvt_pk_f16_f32 v125, v116, -v117
  v_pk_mul_f32 v[42:43], v[24:25], v[24:25] op_sel:[0,0] op_sel_hi:[1,0]
  s_waitcnt lgkmcnt(15)
  v_mfma_f32_32x32x16_f16 v[48:63], v[144:147], v[148:151], v[48:63]
  ds_write_addtid_b32 v124 offset:7344
  v_pk_mul_f32 v[118:119], v[116:117], v[20:21] op_sel:[0,0] op_sel_hi:[1,0]
  v_pk_fma_f32 v[28:29], v[24:25], v[24:25], v[42:43] op_sel:[1,1,0] op_sel_hi:[0,1,1] neg_lo:[1,0,0]
  v_pk_fma_f32 v[116:117], v[116:117], v[20:21], v[118:119] op_sel:[1,1,0] op_sel_hi:[0,1,1] neg_lo:[1,0,0]
  v_cvt_pk_f16_f32 v122, v28, v29
  v_cvt_pk_f16_f32 v120, v116, -v117
  ds_write_addtid_b32 v125 offset:7616
  ds_write_addtid_b32 v47 offset:816
  v_pk_mul_f32 v[118:119], v[116:117], v[20:21] op_sel:[0,0] op_sel_hi:[1,0]
  v_pk_mul_f32 v[42:43], v[34:35], v[22:23] op_sel:[0,0] op_sel_hi:[1,0]
  v_pk_fma_f32 v[116:117], v[116:117], v[20:21], v[118:119] op_sel:[1,1,0] op_sel_hi:[0,1,1] neg_lo:[1,0,0]
  v_cvt_pk_f16_f32 v121, v116, -v117
  v_pk_fma_f32 v[36:37], v[34:35], v[22:23], v[42:43] op_sel:[1,1,0] op_sel_hi:[0,1,1] neg_lo:[1,0,0]
  ds_write_addtid_b32 v120 offset:7888
  v_pk_mul_f32 v[118:119], v[116:117], v[20:21] op_sel:[0,0] op_sel_hi:[1,0]
  v_cvt_pk_f16_f32 v123, v36, v37
  v_pk_fma_f32 v[116:117], v[116:117], v[20:21], v[118:119] op_sel:[1,1,0] op_sel_hi:[0,1,1] neg_lo:[1,0,0]
  ds_write_addtid_b32 v122 offset:1088
  v_cvt_pk_f16_f32 v124, v116, -v117
  ds_write_addtid_b32 v121 offset:8160
  v_pk_mul_f32 v[42:43], v[28:29], v[18:19] op_sel:[0,0] op_sel_hi:[1,0]
  v_pk_mul_f32 v[118:119], v[116:117], v[20:21] op_sel:[0,0] op_sel_hi:[1,0]
  v_pk_fma_f32 v[40:41], v[28:29], v[18:19], v[42:43] op_sel:[1,1,0] op_sel_hi:[0,1,1] neg_lo:[1,0,0]
  v_pk_fma_f32 v[116:117], v[116:117], v[20:21], v[118:119] op_sel:[1,1,0] op_sel_hi:[0,1,1] neg_lo:[1,0,0]
  v_cvt_pk_f16_f32 v125, v116, -v117
  v_cvt_pk_f16_f32 v46, v40, v41
  ds_write_addtid_b32 v124 offset:8432
  s_waitcnt lgkmcnt(15)
  v_mfma_f32_32x32x16_f16 v[48:63], v[152:155], v[156:159], v[48:63]
  v_pk_mul_f32 v[118:119], v[116:117], v[20:21] op_sel:[0,0] op_sel_hi:[1,0]
  ds_write_addtid_b32 v123 offset:3808
  v_pk_fma_f32 v[116:117], v[116:117], v[20:21], v[118:119] op_sel:[1,1,0] op_sel_hi:[0,1,1] neg_lo:[1,0,0]
  v_pk_mul_f32 v[42:43], v[28:29], v[24:25] op_sel:[0,0] op_sel_hi:[1,0]
  v_cvt_pk_f16_f32 v120, v116, -v117
  ds_write_addtid_b32 v125 offset:8704
  v_pk_fma_f32 v[32:33], v[28:29], v[24:25], v[42:43] op_sel:[1,1,0] op_sel_hi:[0,1,1] neg_lo:[1,0,0]
  v_pk_mul_f32 v[118:119], v[116:117], v[20:21] op_sel:[0,0] op_sel_hi:[1,0]
  v_pk_fma_f32 v[116:117], v[116:117], v[20:21], v[118:119] op_sel:[1,1,0] op_sel_hi:[0,1,1] neg_lo:[1,0,0]
  v_cvt_pk_f16_f32 v47, v32, v33
  v_cvt_pk_f16_f32 v121, v116, -v117
  ds_write_addtid_b32 v46 offset:1360
  ds_write_addtid_b32 v120 offset:8976
  v_pk_mul_f32 v[118:119], v[116:117], v[20:21] op_sel:[0,0] op_sel_hi:[1,0]
  v_pk_mul_f32 v[42:43], v[28:29], v[26:27] op_sel:[0,0] op_sel_hi:[1,0]
  v_pk_fma_f32 v[116:117], v[116:117], v[20:21], v[118:119] op_sel:[1,1,0] op_sel_hi:[0,1,1] neg_lo:[1,0,0]
  v_pk_fma_f32 v[40:41], v[28:29], v[26:27], v[42:43] op_sel:[1,1,0] op_sel_hi:[0,1,1] neg_lo:[1,0,0]
  v_cvt_pk_f16_f32 v124, v116, -v117
  ds_write_addtid_b32 v121 offset:9248
  v_cvt_pk_f16_f32 v122, v40, v41
  v_pk_mul_f32 v[118:119], v[116:117], v[20:21] op_sel:[0,0] op_sel_hi:[1,0]
  v_pk_fma_f32 v[116:117], v[116:117], v[20:21], v[118:119] op_sel:[1,1,0] op_sel_hi:[0,1,1] neg_lo:[1,0,0]
  ds_write_addtid_b32 v47 offset:1632
  v_cvt_pk_f16_f32 v125, v116, -v117
  v_pk_mul_f32 v[42:43], v[22:23], v[24:25] op_sel:[0,0] op_sel_hi:[1,0]
  ds_write_addtid_b32 v124 offset:9520
  v_pk_mul_f32 v[118:119], v[116:117], v[20:21] op_sel:[0,0] op_sel_hi:[1,0]
  s_waitcnt lgkmcnt(15)
  v_mfma_f32_32x32x16_f16 v[48:63], v[160:163], v[164:167], v[48:63]
  v_pk_fma_f32 v[40:41], v[22:23], v[24:25], v[42:43] op_sel:[1,1,0] op_sel_hi:[0,1,1] neg_lo:[1,0,0]
  v_pk_fma_f32 v[116:117], v[116:117], v[20:21], v[118:119] op_sel:[1,1,0] op_sel_hi:[0,1,1] neg_lo:[1,0,0]
  v_cvt_pk_f16_f32 v123, v40, v41
  v_cvt_pk_f16_f32 v120, v116, -v117
  ds_write_addtid_b32 v125 offset:9792
  ds_write_addtid_b32 v122 offset:1904
  v_pk_mul_f32 v[118:119], v[116:117], v[20:21] op_sel:[0,0] op_sel_hi:[1,0]
  v_pk_fma_f32 v[116:117], v[116:117], v[20:21], v[118:119] op_sel:[1,1,0] op_sel_hi:[0,1,1] neg_lo:[1,0,0]
  v_pk_mul_f32 v[42:43], v[22:23], v[28:29] op_sel:[0,0] op_sel_hi:[1,0]
  v_cvt_pk_f16_f32 v121, v116, -v117
  v_pk_fma_f32 v[40:41], v[22:23], v[28:29], v[42:43] op_sel:[1,1,0] op_sel_hi:[0,1,1] neg_lo:[1,0,0]
  ds_write_addtid_b32 v120 offset:10064
  v_pk_mul_f32 v[118:119], v[116:117], v[20:21] op_sel:[0,0] op_sel_hi:[1,0]
  v_cvt_pk_f16_f32 v46, v40, v41
  v_pk_fma_f32 v[116:117], v[116:117], v[20:21], v[118:119] op_sel:[1,1,0] op_sel_hi:[0,1,1] neg_lo:[1,0,0]
  v_cvt_pk_f16_f32 v124, v116, -v117
  ds_write_addtid_b32 v123 offset:2448
  ds_write_addtid_b32 v121 offset:10336
  v_pk_mul_f32 v[42:43], v[22:23], v[32:33] op_sel:[0,0] op_sel_hi:[1,0]
  v_pk_mul_f32 v[118:119], v[116:117], v[20:21] op_sel:[0,0] op_sel_hi:[1,0]
  v_pk_fma_f32 v[116:117], v[116:117], v[20:21], v[118:119] op_sel:[1,1,0] op_sel_hi:[0,1,1] neg_lo:[1,0,0]
  v_pk_fma_f32 v[40:41], v[22:23], v[32:33], v[42:43] op_sel:[1,1,0] op_sel_hi:[0,1,1] neg_lo:[1,0,0]
  v_cvt_pk_f16_f32 v125, v116, -v117
  v_cvt_pk_f16_f32 v47, v40, v41
  ds_write_addtid_b32 v124 offset:10608
  v_pk_mul_f32 v[118:119], v[116:117], v[20:21] op_sel:[0,0] op_sel_hi:[1,0]
  ds_write_addtid_b32 v46 offset:2720
  s_waitcnt lgkmcnt(15)
  v_mfma_f32_32x32x16_f16 v[48:63], v[168:171], v[172:175], v[48:63]
  v_pk_fma_f32 v[116:117], v[116:117], v[20:21], v[118:119] op_sel:[1,1,0] op_sel_hi:[0,1,1] neg_lo:[1,0,0]
  v_cvt_pk_f16_f32 v120, v116, -v117
  v_pk_mul_f32 v[42:43], v[34:35], v[28:29] op_sel:[0,0] op_sel_hi:[1,0]
  ds_write_addtid_b32 v125 offset:10880
  v_pk_fma_f32 v[40:41], v[34:35], v[28:29], v[42:43] op_sel:[1,1,0] op_sel_hi:[0,1,1] neg_lo:[1,0,0]
  v_pk_mul_f32 v[118:119], v[116:117], v[20:21] op_sel:[0,0] op_sel_hi:[1,0]
  v_pk_fma_f32 v[116:117], v[116:117], v[20:21], v[118:119] op_sel:[1,1,0] op_sel_hi:[0,1,1] neg_lo:[1,0,0]
  v_cvt_pk_f16_f32 v122, v40, v41
  v_cvt_pk_f16_f32 v121, v116, -v117
  ds_write_addtid_b32 v47 offset:2992
  ds_write_addtid_b32 v120 offset:11152
  v_pk_mul_f32 v[118:119], v[116:117], v[20:21] op_sel:[0,0] op_sel_hi:[1,0]
  v_pk_mul_f32 v[42:43], v[36:37], v[28:29] op_sel:[0,0] op_sel_hi:[1,0]
  v_pk_fma_f32 v[116:117], v[116:117], v[20:21], v[118:119] op_sel:[1,1,0] op_sel_hi:[0,1,1] neg_lo:[1,0,0]
  v_cvt_pk_f16_f32 v124, v116, -v117
  v_pk_fma_f32 v[40:41], v[36:37], v[28:29], v[42:43] op_sel:[1,1,0] op_sel_hi:[0,1,1] neg_lo:[1,0,0]
  ds_write_addtid_b32 v121 offset:11424
  v_cvt_pk_f16_f32 v123, v40, v41
  v_pk_mul_f32 v[118:119], v[116:117], v[20:21] op_sel:[0,0] op_sel_hi:[1,0]
  v_pk_fma_f32 v[116:117], v[116:117], v[20:21], v[118:119] op_sel:[1,1,0] op_sel_hi:[0,1,1] neg_lo:[1,0,0]
  ds_write_addtid_b32 v122 offset:3536
  v_cvt_pk_f16_f32 v125, v116, -v117
  ds_write_addtid_b32 v124 offset:11696
  v_pk_mul_f32 v[42:43], v[34:35], v[34:35] op_sel:[0,0] op_sel_hi:[1,0]
  v_pk_mul_f32 v[118:119], v[116:117], v[20:21] op_sel:[0,0] op_sel_hi:[1,0]
  v_pk_fma_f32 v[36:37], v[34:35], v[34:35], v[42:43] op_sel:[1,1,0] op_sel_hi:[0,1,1] neg_lo:[1,0,0]
  v_pk_fma_f32 v[116:117], v[116:117], v[20:21], v[118:119] op_sel:[1,1,0] op_sel_hi:[0,1,1] neg_lo:[1,0,0]
  s_waitcnt lgkmcnt(15)
  v_mfma_f32_32x32x16_f16 v[48:63], v[176:179], v[180:183], v[48:63]
  v_cvt_pk_f16_f32 v120, v116, -v117
  v_cvt_pk_f16_f32 v46, v36, v37
  ds_write_addtid_b32 v125 offset:11968
  ds_write_addtid_b32 v123 offset:4080
  v_pk_mul_f32 v[118:119], v[116:117], v[20:21] op_sel:[0,0] op_sel_hi:[1,0]
  v_pk_fma_f32 v[116:117], v[116:117], v[20:21], v[118:119] op_sel:[1,1,0] op_sel_hi:[0,1,1] neg_lo:[1,0,0]
  v_pk_mul_f32 v[42:43], v[36:37], v[22:23] op_sel:[0,0] op_sel_hi:[1,0]
  v_cvt_pk_f16_f32 v121, v116, -v117
  ds_write_addtid_b32 v120 offset:12240
  v_pk_fma_f32 v[40:41], v[36:37], v[22:23], v[42:43] op_sel:[1,1,0] op_sel_hi:[0,1,1] neg_lo:[1,0,0]
  v_pk_mul_f32 v[118:119], v[116:117], v[20:21] op_sel:[0,0] op_sel_hi:[1,0]
  v_cvt_pk_f16_f32 v47, v40, v41
  v_pk_fma_f32 v[116:117], v[116:117], v[20:21], v[118:119] op_sel:[1,1,0] op_sel_hi:[0,1,1] neg_lo:[1,0,0]
  v_cvt_pk_f16_f32 v124, v116, -v117
  ds_write_addtid_b32 v46 offset:4352
  ds_write_addtid_b32 v121 offset:12512
  v_pk_mul_f32 v[42:43], v[36:37], v[34:35] op_sel:[0,0] op_sel_hi:[1,0]
  v_pk_mul_f32 v[118:119], v[116:117], v[20:21] op_sel:[0,0] op_sel_hi:[1,0]
  v_pk_fma_f32 v[116:117], v[116:117], v[20:21], v[118:119] op_sel:[1,1,0] op_sel_hi:[0,1,1] neg_lo:[1,0,0]
  v_pk_fma_f32 v[38:39], v[36:37], v[34:35], v[42:43] op_sel:[1,1,0] op_sel_hi:[0,1,1] neg_lo:[1,0,0]
  v_cvt_pk_f16_f32 v125, v116, -v117
  ds_write_addtid_b32 v124 offset:12784
  v_cvt_pk_f16_f32 v122, v38, v39
  v_pk_mul_f32 v[118:119], v[116:117], v[20:21] op_sel:[0,0] op_sel_hi:[1,0]
  ds_write_addtid_b32 v47 offset:4624
  v_pk_fma_f32 v[116:117], v[116:117], v[20:21], v[118:119] op_sel:[1,1,0] op_sel_hi:[0,1,1] neg_lo:[1,0,0]
  v_cvt_pk_f16_f32 v120, v116, -v117
  s_waitcnt lgkmcnt(15)
  v_mfma_f32_32x32x16_f16 v[48:63], v[184:187], v[188:191], v[48:63]
  v_pk_mul_f32 v[42:43], v[38:39], v[22:23] op_sel:[0,0] op_sel_hi:[1,0]
  ds_write_addtid_b32 v125 offset:13056
  v_pk_mul_f32 v[118:119], v[116:117], v[20:21] op_sel:[0,0] op_sel_hi:[1,0]
  v_pk_fma_f32 v[40:41], v[38:39], v[22:23], v[42:43] op_sel:[1,1,0] op_sel_hi:[0,1,1] neg_lo:[1,0,0]
  v_pk_fma_f32 v[116:117], v[116:117], v[20:21], v[118:119] op_sel:[1,1,0] op_sel_hi:[0,1,1] neg_lo:[1,0,0]
  v_cvt_pk_f16_f32 v123, v40, v41
  v_cvt_pk_f16_f32 v121, v116, -v117
  ds_write_addtid_b32 v120 offset:13328
  ds_write_addtid_b32 v122 offset:4896
  v_pk_mul_f32 v[118:119], v[116:117], v[20:21] op_sel:[0,0] op_sel_hi:[1,0]
  v_pk_mul_f32 v[42:43], v[36:37], v[36:37] op_sel:[0,0] op_sel_hi:[1,0]
  v_pk_fma_f32 v[116:117], v[116:117], v[20:21], v[118:119] op_sel:[1,1,0] op_sel_hi:[0,1,1] neg_lo:[1,0,0]
  v_cvt_pk_f16_f32 v124, v116, -v117
  v_pk_fma_f32 v[40:41], v[36:37], v[36:37], v[42:43] op_sel:[1,1,0] op_sel_hi:[0,1,1] neg_lo:[1,0,0]
  ds_write_addtid_b32 v121 offset:13600
  v_pk_mul_f32 v[118:119], v[116:117], v[20:21] op_sel:[0,0] op_sel_hi:[1,0]
  v_cvt_pk_f16_f32 v46, v40, v41
  v_pk_fma_f32 v[116:117], v[116:117], v[20:21], v[118:119] op_sel:[1,1,0] op_sel_hi:[0,1,1] neg_lo:[1,0,0]
  ds_write_addtid_b32 v123 offset:5168
  v_cvt_pk_f16_f32 v125, v116, -v117
  ds_write_addtid_b32 v124 offset:13872
  ds_write_addtid_b32 v46 offset:5440
  ds_write_addtid_b32 v125 offset:14144
  ds_read_b128 v[128:131], v13 offset:14416
  ds_read_b128 v[132:135], v13 offset:20128
  ds_read_b128 v[136:139], v13 offset:14448
  ds_read_b128 v[140:143], v13 offset:20160
  ds_read_b128 v[144:147], v13 offset:14480
  ds_read_b128 v[148:151], v13 offset:20192
  ds_read_b128 v[152:155], v13 offset:14512
  ds_read_b128 v[156:159], v13 offset:20224
  ds_read_b128 v[160:163], v13 offset:14544
  ds_read_b128 v[164:167], v13 offset:20256
  ds_read_b128 v[168:171], v13 offset:14576
  ds_read_b128 v[172:175], v13 offset:20288
  ds_read_b128 v[176:179], v13 offset:14608
  ds_read_b128 v[180:183], v13 offset:20320
  ds_read_b128 v[184:187], v13 offset:14640
  ds_read_b128 v[188:191], v13 offset:20352
  s_waitcnt lgkmcnt(15)
  v_readfirstlane_b32 s72, v199
  v_lshlrev_b32 v196, 4, v1
  s_and_b32 s51, s2, 7
  s_lshl_b32 s51, s51, 10
  s_add_u32 s51, s51, 5439488
  s_mov_b64 s[54:55], -1
  buffer_load_dwordx4 v[192:195], v196, s[8:11], s51 offen sc1
  s_add_u32 s43, s75, 0
  s_mov_b32 m0, s43
  v_lshlrev_b32 v108, 16, v108
  v_lshlrev_b32 v109, 16, v109
  v_mul_f32 v4, v14, v108
  v_exp_f32 v4, v4
  v_mul_f32 v5, v109, v15
  v_mul_f32 v5, 0x3e22f983, v5
  v_cvt_pk_bf16_f32 v4, 0, v4
  v_mul_f32 v4, v4, v15
  v_mul_f32 v4, v4, v14
  v_exp_f32 v6, -v4
  v_fract_f32 v7, v5
  v_cos_f32 v18, v7
  v_sin_f32 v19, v7
  s_nop 0
  v_mul_f32 v18, v18, v6
  v_mul_f32 v19, v19, v6
  v_mul_f32 v8, 0x41000000, v4
  v_mul_f32 v9, 0x41000000, v5
  v_exp_f32 v8, -v8
  v_fract_f32 v9, v9
  v_cos_f32 v20, v9
  v_sin_f32 v21, v9
  s_nop 0
  v_mul_f32 v20, v20, v8
  v_mul_f32 v21, v21, v8
  v_mul_f32 v6, 0x43800000, v4
  v_mul_f32 v7, 0x43800000, v5
  v_exp_f32 v6, -v6
  v_fract_f32 v7, v7
  v_cos_f32 v22, v7
  s_waitcnt lgkmcnt(14)
  v_mfma_f32_32x32x16_f16 v[48:63], v[128:131], v[132:135], v[48:63]
  v_sin_f32 v23, v7
  s_nop 0
  v_mul_f32 v22, v22, v6
  v_mul_f32 v23, v23, v6
  v_lshlrev_b32 v110, 16, v110
  v_lshlrev_b32 v111, 16, v111
  v_mul_f32 v44, v110, v11
  v_mul_f32 v45, v111, v11
  v_mov_b32 v46, 0x3c00
  v_cvt_pk_f16_f32 v120, v44, -v45
  v_pk_mul_f32 v[118:119], v[44:45], v[20:21] op_sel:[0,0] op_sel_hi:[1,0]
  v_cvt_pk_f16_f32 v47, v18, v19
  v_pk_fma_f32 v[116:117], v[44:45], v[20:21], v[118:119] op_sel:[1,1,0] op_sel_hi:[0,1,1] neg_lo:[1,0,0]
  v_cvt_pk_f16_f32 v121, v116, -v117
  ds_write_addtid_b32 v46 offset:0
  ds_write_addtid_b32 v120 offset:5712
  v_pk_mul_f32 v[42:43], v[18:19], v[18:19] op_sel:[0,0] op_sel_hi:[1,0]
  v_pk_mul_f32 v[118:119], v[116:117], v[20:21] op_sel:[0,0] op_sel_hi:[1,0]
  v_pk_fma_f32 v[116:117], v[116:117], v[20:21], v[118:119] op_sel:[1,1,0] op_sel_hi:[0,1,1] neg_lo:[1,0,0]
  v_pk_fma_f32 v[24:25], v[18:19], v[18:19], v[42:43] op_sel:[1,1,0] op_sel_hi:[0,1,1] neg_lo:[1,0,0]
  v_cvt_pk_f16_f32 v124, v116, -v117
  ds_write_addtid_b32 v121 offset:5984
  v_cvt_pk_f16_f32 v122, v24, v25
  v_pk_mul_f32 v[118:119], v[116:117], v[20:21] op_sel:[0,0] op_sel_hi:[1,0]
  ds_write_addtid_b32 v47 offset:272
  v_pk_fma_f32 v[116:117], v[116:117], v[20:21], v[118:119] op_sel:[1,1,0] op_sel_hi:[0,1,1] neg_lo:[1,0,0]
  v_cvt_pk_f16_f32 v125, v116, -v117
  s_waitcnt lgkmcnt(15)
  v_mfma_f32_32x32x16_f16 v[48:63], v[136:139], v[140:143], v[48:63]
  v_cvt_pk_f16_f32 v123, v22, v23
  ds_write_addtid_b32 v124 offset:6256
  ds_write_addtid_b32 v122 offset:544
  v_pk_mul_f32 v[118:119], v[116:117], v[20:21] op_sel:[0,0] op_sel_hi:[1,0]
  v_pk_fma_f32 v[116:117], v[116:117], v[20:21], v[118:119] op_sel:[1,1,0] op_sel_hi:[0,1,1] neg_lo:[1,0,0]
  v_pk_mul_f32 v[42:43], v[22:23], v[22:23] op_sel:[0,0] op_sel_hi:[1,0]
  v_cvt_pk_f16_f32 v120, v116, -v117
  ds_write_addtid_b32 v125 offset:6528
  v_pk_fma_f32 v[34:35], v[22:23], v[22:23], v[42:43] op_sel:[1,1,0] op_sel_hi:[0,1,1] neg_lo:[1,0,0]
  v_pk_mul_f32 v[118:119], v[116:117], v[20:21] op_sel:[0,0] op_sel_hi:[1,0]
  v_cvt_pk_f16_f32 v46, v34, v35
  v_pk_fma_f32 v[116:117], v[116:117], v[20:21], v[118:119] op_sel:[1,1,0] op_sel_hi:[0,1,1] neg_lo:[1,0,0]
  v_cvt_pk_f16_f32 v121, v116, -v117
  ds_write_addtid_b32 v123 offset:2176
  ds_write_addtid_b32 v120 offset:6800
  v_pk_mul_f32 v[42:43], v[24:25], v[18:19] op_sel:[0,0] op_sel_hi:[1,0]
  v_pk_mul_f32 v[118:119], v[116:117], v[20:21] op_sel:[0,0] op_sel_hi:[1,0]
  v_pk_fma_f32 v[116:117], v[116:117], v[20:21], v[118:119] op_sel:[1,1,0] op_sel_hi:[0,1,1] neg_lo:[1,0,0]
  v_pk_fma_f32 v[26:27], v[24:25], v[18:19], v[42:43] op_sel:[1,1,0] op_sel_hi:[0,1,1] neg_lo:[1,0,0]
  v_cvt_pk_f16_f32 v124, v116, -v117
  ds_write_addtid_b32 v121 offset:7072
  v_cvt_pk_f16_f32 v47, v26, v27
  v_pk_mul_f32 v[118:119], v[116:117], v[20:21] op_sel:[0,0] op_sel_hi:[1,0]
  ds_write_addtid_b32 v46 offset:3264
  v_pk_fma_f32 v[116:117], v[116:117], v[20:21], v[118:119] op_sel:[1,1,0] op_sel_hi:[0,1,1] neg_lo:[1,0,0]
  v_cvt_pk_f16_f32 v125, v116, -v117
  v_pk_mul_f32 v[42:43], v[24:25], v[24:25] op_sel:[0,0] op_sel_hi:[1,0]
  s_waitcnt lgkmcnt(15)
  v_mfma_f32_32x32x16_f16 v[48:63], v[144:147], v[148:151], v[48:63]
  ds_write_addtid_b32 v124 offset:7344
  v_pk_mul_f32 v[118:119], v[116:117], v[20:21] op_sel:[0,0] op_sel_hi:[1,0]
  v_pk_fma_f32 v[28:29], v[24:25], v[24:25], v[42:43] op_sel:[1,1,0] op_sel_hi:[0,1,1] neg_lo:[1,0,0]
  v_pk_fma_f32 v[116:117], v[116:117], v[20:21], v[118:119] op_sel:[1,1,0] op_sel_hi:[0,1,1] neg_lo:[1,0,0]
  v_cvt_pk_f16_f32 v122, v28, v29
  v_cvt_pk_f16_f32 v120, v116, -v117
  ds_write_addtid_b32 v125 offset:7616
  ds_write_addtid_b32 v47 offset:816
  v_pk_mul_f32 v[118:119], v[116:117], v[20:21] op_sel:[0,0] op_sel_hi:[1,0]
  v_pk_mul_f32 v[42:43], v[34:35], v[22:23] op_sel:[0,0] op_sel_hi:[1,0]
  v_pk_fma_f32 v[116:117], v[116:117], v[20:21], v[118:119] op_sel:[1,1,0] op_sel_hi:[0,1,1] neg_lo:[1,0,0]
  v_cvt_pk_f16_f32 v121, v116, -v117
  v_pk_fma_f32 v[36:37], v[34:35], v[22:23], v[42:43] op_sel:[1,1,0] op_sel_hi:[0,1,1] neg_lo:[1,0,0]
  ds_write_addtid_b32 v120 offset:7888
  v_pk_mul_f32 v[118:119], v[116:117], v[20:21] op_sel:[0,0] op_sel_hi:[1,0]
  v_cvt_pk_f16_f32 v123, v36, v37
  v_pk_fma_f32 v[116:117], v[116:117], v[20:21], v[118:119] op_sel:[1,1,0] op_sel_hi:[0,1,1] neg_lo:[1,0,0]
  ds_write_addtid_b32 v122 offset:1088
  v_cvt_pk_f16_f32 v124, v116, -v117
  ds_write_addtid_b32 v121 offset:8160
  v_pk_mul_f32 v[42:43], v[28:29], v[18:19] op_sel:[0,0] op_sel_hi:[1,0]
  v_pk_mul_f32 v[118:119], v[116:117], v[20:21] op_sel:[0,0] op_sel_hi:[1,0]
  v_pk_fma_f32 v[40:41], v[28:29], v[18:19], v[42:43] op_sel:[1,1,0] op_sel_hi:[0,1,1] neg_lo:[1,0,0]
  v_pk_fma_f32 v[116:117], v[116:117], v[20:21], v[118:119] op_sel:[1,1,0] op_sel_hi:[0,1,1] neg_lo:[1,0,0]
  v_cvt_pk_f16_f32 v125, v116, -v117
  v_cvt_pk_f16_f32 v46, v40, v41
  ds_write_addtid_b32 v124 offset:8432
  s_waitcnt lgkmcnt(15)
  v_mfma_f32_32x32x16_f16 v[48:63], v[152:155], v[156:159], v[48:63]
  v_pk_mul_f32 v[118:119], v[116:117], v[20:21] op_sel:[0,0] op_sel_hi:[1,0]
  ds_write_addtid_b32 v123 offset:3808
  v_pk_fma_f32 v[116:117], v[116:117], v[20:21], v[118:119] op_sel:[1,1,0] op_sel_hi:[0,1,1] neg_lo:[1,0,0]
  v_pk_mul_f32 v[42:43], v[28:29], v[24:25] op_sel:[0,0] op_sel_hi:[1,0]
  v_cvt_pk_f16_f32 v120, v116, -v117
  ds_write_addtid_b32 v125 offset:8704
  v_pk_fma_f32 v[32:33], v[28:29], v[24:25], v[42:43] op_sel:[1,1,0] op_sel_hi:[0,1,1] neg_lo:[1,0,0]
  v_pk_mul_f32 v[118:119], v[116:117], v[20:21] op_sel:[0,0] op_sel_hi:[1,0]
  v_pk_fma_f32 v[116:117], v[116:117], v[20:21], v[118:119] op_sel:[1,1,0] op_sel_hi:[0,1,1] neg_lo:[1,0,0]
  v_cvt_pk_f16_f32 v47, v32, v33
  v_cvt_pk_f16_f32 v121, v116, -v117
  ds_write_addtid_b32 v46 offset:1360
  ds_write_addtid_b32 v120 offset:8976
  v_pk_mul_f32 v[118:119], v[116:117], v[20:21] op_sel:[0,0] op_sel_hi:[1,0]
  v_pk_mul_f32 v[42:43], v[28:29], v[26:27] op_sel:[0,0] op_sel_hi:[1,0]
  v_pk_fma_f32 v[116:117], v[116:117], v[20:21], v[118:119] op_sel:[1,1,0] op_sel_hi:[0,1,1] neg_lo:[1,0,0]
  v_pk_fma_f32 v[40:41], v[28:29], v[26:27], v[42:43] op_sel:[1,1,0] op_sel_hi:[0,1,1] neg_lo:[1,0,0]
  v_cvt_pk_f16_f32 v124, v116, -v117
  ds_write_addtid_b32 v121 offset:9248
  v_cvt_pk_f16_f32 v122, v40, v41
  v_pk_mul_f32 v[118:119], v[116:117], v[20:21] op_sel:[0,0] op_sel_hi:[1,0]
  v_pk_fma_f32 v[116:117], v[116:117], v[20:21], v[118:119] op_sel:[1,1,0] op_sel_hi:[0,1,1] neg_lo:[1,0,0]
  ds_write_addtid_b32 v47 offset:1632
  v_cvt_pk_f16_f32 v125, v116, -v117
  v_pk_mul_f32 v[42:43], v[22:23], v[24:25] op_sel:[0,0] op_sel_hi:[1,0]
  ds_write_addtid_b32 v124 offset:9520
  v_pk_mul_f32 v[118:119], v[116:117], v[20:21] op_sel:[0,0] op_sel_hi:[1,0]
  s_waitcnt lgkmcnt(15)
  v_mfma_f32_32x32x16_f16 v[48:63], v[160:163], v[164:167], v[48:63]
  v_pk_fma_f32 v[40:41], v[22:23], v[24:25], v[42:43] op_sel:[1,1,0] op_sel_hi:[0,1,1] neg_lo:[1,0,0]
  v_pk_fma_f32 v[116:117], v[116:117], v[20:21], v[118:119] op_sel:[1,1,0] op_sel_hi:[0,1,1] neg_lo:[1,0,0]
  v_cvt_pk_f16_f32 v123, v40, v41
  v_cvt_pk_f16_f32 v120, v116, -v117
  ds_write_addtid_b32 v125 offset:9792
  ds_write_addtid_b32 v122 offset:1904
  v_pk_mul_f32 v[118:119], v[116:117], v[20:21] op_sel:[0,0] op_sel_hi:[1,0]
  v_pk_fma_f32 v[116:117], v[116:117], v[20:21], v[118:119] op_sel:[1,1,0] op_sel_hi:[0,1,1] neg_lo:[1,0,0]
  v_pk_mul_f32 v[42:43], v[22:23], v[28:29] op_sel:[0,0] op_sel_hi:[1,0]
  v_cvt_pk_f16_f32 v121, v116, -v117
  v_pk_fma_f32 v[40:41], v[22:23], v[28:29], v[42:43] op_sel:[1,1,0] op_sel_hi:[0,1,1] neg_lo:[1,0,0]
  ds_write_addtid_b32 v120 offset:10064
  v_pk_mul_f32 v[118:119], v[116:117], v[20:21] op_sel:[0,0] op_sel_hi:[1,0]
  v_cvt_pk_f16_f32 v46, v40, v41
  v_pk_fma_f32 v[116:117], v[116:117], v[20:21], v[118:119] op_sel:[1,1,0] op_sel_hi:[0,1,1] neg_lo:[1,0,0]
  v_cvt_pk_f16_f32 v124, v116, -v117
  ds_write_addtid_b32 v123 offset:2448
  ds_write_addtid_b32 v121 offset:10336
  v_pk_mul_f32 v[42:43], v[22:23], v[32:33] op_sel:[0,0] op_sel_hi:[1,0]
  v_pk_mul_f32 v[118:119], v[116:117], v[20:21] op_sel:[0,0] op_sel_hi:[1,0]
  v_pk_fma_f32 v[116:117], v[116:117], v[20:21], v[118:119] op_sel:[1,1,0] op_sel_hi:[0,1,1] neg_lo:[1,0,0]
  v_pk_fma_f32 v[40:41], v[22:23], v[32:33], v[42:43] op_sel:[1,1,0] op_sel_hi:[0,1,1] neg_lo:[1,0,0]
  v_cvt_pk_f16_f32 v125, v116, -v117
  v_cvt_pk_f16_f32 v47, v40, v41
  ds_write_addtid_b32 v124 offset:10608
  v_pk_mul_f32 v[118:119], v[116:117], v[20:21] op_sel:[0,0] op_sel_hi:[1,0]
  ds_write_addtid_b32 v46 offset:2720
  s_waitcnt lgkmcnt(15)
  v_mfma_f32_32x32x16_f16 v[48:63], v[168:171], v[172:175], v[48:63]
  v_pk_fma_f32 v[116:117], v[116:117], v[20:21], v[118:119] op_sel:[1,1,0] op_sel_hi:[0,1,1] neg_lo:[1,0,0]
  v_cvt_pk_f16_f32 v120, v116, -v117
  v_pk_mul_f32 v[42:43], v[34:35], v[28:29] op_sel:[0,0] op_sel_hi:[1,0]
  ds_write_addtid_b32 v125 offset:10880
  v_pk_fma_f32 v[40:41], v[34:35], v[28:29], v[42:43] op_sel:[1,1,0] op_sel_hi:[0,1,1] neg_lo:[1,0,0]
  v_pk_mul_f32 v[118:119], v[116:117], v[20:21] op_sel:[0,0] op_sel_hi:[1,0]
  v_pk_fma_f32 v[116:117], v[116:117], v[20:21], v[118:119] op_sel:[1,1,0] op_sel_hi:[0,1,1] neg_lo:[1,0,0]
  v_cvt_pk_f16_f32 v122, v40, v41
  v_cvt_pk_f16_f32 v121, v116, -v117
  ds_write_addtid_b32 v47 offset:2992
  ds_write_addtid_b32 v120 offset:11152
  v_pk_mul_f32 v[118:119], v[116:117], v[20:21] op_sel:[0,0] op_sel_hi:[1,0]
  v_pk_mul_f32 v[42:43], v[36:37], v[28:29] op_sel:[0,0] op_sel_hi:[1,0]
  v_pk_fma_f32 v[116:117], v[116:117], v[20:21], v[118:119] op_sel:[1,1,0] op_sel_hi:[0,1,1] neg_lo:[1,0,0]
  v_cvt_pk_f16_f32 v124, v116, -v117
  v_pk_fma_f32 v[40:41], v[36:37], v[28:29], v[42:43] op_sel:[1,1,0] op_sel_hi:[0,1,1] neg_lo:[1,0,0]
  ds_write_addtid_b32 v121 offset:11424
  v_cvt_pk_f16_f32 v123, v40, v41
  v_pk_mul_f32 v[118:119], v[116:117], v[20:21] op_sel:[0,0] op_sel_hi:[1,0]
  v_pk_fma_f32 v[116:117], v[116:117], v[20:21], v[118:119] op_sel:[1,1,0] op_sel_hi:[0,1,1] neg_lo:[1,0,0]
  ds_write_addtid_b32 v122 offset:3536
  v_cvt_pk_f16_f32 v125, v116, -v117
  ds_write_addtid_b32 v124 offset:11696
  v_pk_mul_f32 v[42:43], v[34:35], v[34:35] op_sel:[0,0] op_sel_hi:[1,0]
  v_pk_mul_f32 v[118:119], v[116:117], v[20:21] op_sel:[0,0] op_sel_hi:[1,0]
  v_pk_fma_f32 v[36:37], v[34:35], v[34:35], v[42:43] op_sel:[1,1,0] op_sel_hi:[0,1,1] neg_lo:[1,0,0]
  v_pk_fma_f32 v[116:117], v[116:117], v[20:21], v[118:119] op_sel:[1,1,0] op_sel_hi:[0,1,1] neg_lo:[1,0,0]
  s_waitcnt lgkmcnt(15)
  v_mfma_f32_32x32x16_f16 v[48:63], v[176:179], v[180:183], v[48:63]
  v_cvt_pk_f16_f32 v120, v116, -v117
  v_cvt_pk_f16_f32 v46, v36, v37
  ds_write_addtid_b32 v125 offset:11968
  ds_write_addtid_b32 v123 offset:4080
  v_pk_mul_f32 v[118:119], v[116:117], v[20:21] op_sel:[0,0] op_sel_hi:[1,0]
  v_pk_fma_f32 v[116:117], v[116:117], v[20:21], v[118:119] op_sel:[1,1,0] op_sel_hi:[0,1,1] neg_lo:[1,0,0]
  v_pk_mul_f32 v[42:43], v[36:37], v[22:23] op_sel:[0,0] op_sel_hi:[1,0]
  v_cvt_pk_f16_f32 v121, v116, -v117
  ds_write_addtid_b32 v120 offset:12240
  v_pk_fma_f32 v[40:41], v[36:37], v[22:23], v[42:43] op_sel:[1,1,0] op_sel_hi:[0,1,1] neg_lo:[1,0,0]
  v_pk_mul_f32 v[118:119], v[116:117], v[20:21] op_sel:[0,0] op_sel_hi:[1,0]
  v_cvt_pk_f16_f32 v47, v40, v41
  v_pk_fma_f32 v[116:117], v[116:117], v[20:21], v[118:119] op_sel:[1,1,0] op_sel_hi:[0,1,1] neg_lo:[1,0,0]
  v_cvt_pk_f16_f32 v124, v116, -v117
  ds_write_addtid_b32 v46 offset:4352
  ds_write_addtid_b32 v121 offset:12512
  v_pk_mul_f32 v[42:43], v[36:37], v[34:35] op_sel:[0,0] op_sel_hi:[1,0]
  v_pk_mul_f32 v[118:119], v[116:117], v[20:21] op_sel:[0,0] op_sel_hi:[1,0]
  v_pk_fma_f32 v[116:117], v[116:117], v[20:21], v[118:119] op_sel:[1,1,0] op_sel_hi:[0,1,1] neg_lo:[1,0,0]
  v_pk_fma_f32 v[38:39], v[36:37], v[34:35], v[42:43] op_sel:[1,1,0] op_sel_hi:[0,1,1] neg_lo:[1,0,0]
  v_cvt_pk_f16_f32 v125, v116, -v117
  ds_write_addtid_b32 v124 offset:12784
  v_cvt_pk_f16_f32 v122, v38, v39
  v_pk_mul_f32 v[118:119], v[116:117], v[20:21] op_sel:[0,0] op_sel_hi:[1,0]
  ds_write_addtid_b32 v47 offset:4624
  v_pk_fma_f32 v[116:117], v[116:117], v[20:21], v[118:119] op_sel:[1,1,0] op_sel_hi:[0,1,1] neg_lo:[1,0,0]
  v_cvt_pk_f16_f32 v120, v116, -v117
  s_waitcnt lgkmcnt(15)
  v_mfma_f32_32x32x16_f16 v[48:63], v[184:187], v[188:191], v[48:63]
  v_pk_mul_f32 v[42:43], v[38:39], v[22:23] op_sel:[0,0] op_sel_hi:[1,0]
  ds_write_addtid_b32 v125 offset:13056
  v_pk_mul_f32 v[118:119], v[116:117], v[20:21] op_sel:[0,0] op_sel_hi:[1,0]
  v_pk_fma_f32 v[40:41], v[38:39], v[22:23], v[42:43] op_sel:[1,1,0] op_sel_hi:[0,1,1] neg_lo:[1,0,0]
  v_pk_fma_f32 v[116:117], v[116:117], v[20:21], v[118:119] op_sel:[1,1,0] op_sel_hi:[0,1,1] neg_lo:[1,0,0]
  v_cvt_pk_f16_f32 v123, v40, v41
  v_cvt_pk_f16_f32 v121, v116, -v117
  ds_write_addtid_b32 v120 offset:13328
  ds_write_addtid_b32 v122 offset:4896
  v_pk_mul_f32 v[118:119], v[116:117], v[20:21] op_sel:[0,0] op_sel_hi:[1,0]
  v_pk_mul_f32 v[42:43], v[36:37], v[36:37] op_sel:[0,0] op_sel_hi:[1,0]
  v_pk_fma_f32 v[116:117], v[116:117], v[20:21], v[118:119] op_sel:[1,1,0] op_sel_hi:[0,1,1] neg_lo:[1,0,0]
  v_cvt_pk_f16_f32 v124, v116, -v117
  v_pk_fma_f32 v[40:41], v[36:37], v[36:37], v[42:43] op_sel:[1,1,0] op_sel_hi:[0,1,1] neg_lo:[1,0,0]
  ds_write_addtid_b32 v121 offset:13600
  v_pk_mul_f32 v[118:119], v[116:117], v[20:21] op_sel:[0,0] op_sel_hi:[1,0]
  v_cvt_pk_f16_f32 v46, v40, v41
  v_pk_fma_f32 v[116:117], v[116:117], v[20:21], v[118:119] op_sel:[1,1,0] op_sel_hi:[0,1,1] neg_lo:[1,0,0]
  ds_write_addtid_b32 v123 offset:5168
  v_cvt_pk_f16_f32 v125, v116, -v117
  ds_write_addtid_b32 v124 offset:13872
  ds_write_addtid_b32 v46 offset:5440
  ds_write_addtid_b32 v125 offset:14144
  ds_read_b128 v[128:131], v13 offset:0
  ds_read_b128 v[132:135], v13 offset:5712
  ds_read_b128 v[136:139], v13 offset:32
  ds_read_b128 v[140:143], v13 offset:5744
  ds_read_b128 v[144:147], v13 offset:64
  ds_read_b128 v[148:151], v13 offset:5776
  ds_read_b128 v[152:155], v13 offset:96
  ds_read_b128 v[156:159], v13 offset:5808
  ds_read_b128 v[160:163], v13 offset:128
  ds_read_b128 v[164:167], v13 offset:5840
  ds_read_b128 v[168:171], v13 offset:160
  ds_read_b128 v[172:175], v13 offset:5872
  ds_read_b128 v[176:179], v13 offset:192
  ds_read_b128 v[180:183], v13 offset:5904
  ds_read_b128 v[184:187], v13 offset:224
  ds_read_b128 v[188:191], v13 offset:5936
  s_mov_b32 s50, 0
  s_waitcnt vmcnt(0)
  v_xor_b32 v192, s72, v192
  v_xor_b32 v193, s72, v193
  v_xor_b32 v194, s72, v194
  v_xor_b32 v195, s72, v195
  v_or3_b32 v197, v192, v193, v194
  v_or_b32 v197, v197, v195
  v_cmp_ne_u32 vcc, 0, v197
  s_and_b64 s[54:55], s[54:55], vcc
  s_cmp_eq_u64 s[54:55], 0
  s_cbranch_scc0 kg_noearly
  v_lshrrev_b32 v216, 2, v1
  s_movk_i32 s52, 10240
  v_mul_lo_u32 v217, v216, s52
  v_and_b32 v218, 3, v1
  v_lshl_add_u32 v217, v218, 4, v217
  s_mul_i32 s52, s3, 655360
  s_lshl_b32 s53, s2, 6
  s_add_u32 s52, s52, s53
  s_add_u32 s52, s52, 0
  buffer_load_dwordx4 v[200:203], v217, s[8:11], s52 offen sc1
  s_add_u32 s52, s52, 163840
  buffer_load_dwordx4 v[204:207], v217, s[8:11], s52 offen sc1
  s_add_u32 s52, s52, 163840
  buffer_load_dwordx4 v[208:211], v217, s[8:11], s52 offen sc1
  s_add_u32 s52, s52, 163840
  buffer_load_dwordx4 v[212:215], v217, s[8:11], s52 offen sc1
  s_movk_i32 s52, 30432
  v_mul_lo_u32 v218, v218, s52
  v_lshl_add_u32 v218, v216, 4, v218
  s_lshl_b32 s52, s3, 10
  s_add_u32 s52, s52, 19744
  v_add_u32 v218, s52, v218
  s_mov_b32 s50, 1
  s_branch kg_early_done
kg_noearly:
  s_mov_b64 exec, s[54:55]
  buffer_load_dwordx4 v[192:195], v196, s[8:11], s51 offen sc1
  s_mov_b64 exec, -1
kg_early_done:
  v_and_b32 v14, 31, v1
  v_lshrrev_b32 v15, 5, v1
  v_lshlrev_b32 v16, 4, v14
  v_lshl_add_u32 v16, v15, 3, v16
  v_sub_u32 v17, 29336, v16
  v_add_u32 v17, s75, v17
  v_add_u32 v16, 29856, v16
  v_add_u32 v16, s75, v16
  v_lshlrev_b32 v18, 3, v14
  v_add_u32 v18, 29344, v18
  v_add_u32 v19, 4, v18
  v_lshlrev_b32 v20, 2, v14
  v_add_u32 v20, 29600, v20
  v_add_u32 v21, 128, v20
  v_cmp_eq_u32 vcc, 0, v15
  s_nop 1
  v_cndmask_b32 v18, v20, v18, vcc
  v_cndmask_b32 v19, v21, v19, vcc
  v_add_u32 v18, s75, v18
  v_add_u32 v19, s75, v19
  s_waitcnt lgkmcnt(14)
  v_mfma_f32_32x32x16_f16 v[48:63], v[128:131], v[132:135], v[48:63]
  s_add_u32 s43, s75, 28832
  v_sub_u32 v4, 127, v1
  v_add_u32 v5, 1, v4
  v_and_b32 v6, 31, v4
  s_waitcnt lgkmcnt(12)
  v_mfma_f32_32x32x16_f16 v[48:63], v[136:139], v[140:143], v[48:63]
  v_lshrrev_b32 v7, 5, v4
  v_lshlrev_b32 v6, 4, v6
  v_lshl_add_u32 v6, v7, 1, v6
  v_and_b32 v8, 31, v5
  s_waitcnt lgkmcnt(10)
  v_mfma_f32_32x32x16_f16 v[48:63], v[144:147], v[148:151], v[48:63]
  v_lshrrev_b32 v7, 5, v5
  v_lshlrev_b32 v8, 4, v8
  v_lshl_add_u32 v8, v7, 1, v8
  v_add_u32 v6, s43, v6
  s_waitcnt lgkmcnt(8)
  v_mfma_f32_32x32x16_f16 v[48:63], v[152:155], v[156:159], v[48:63]
  v_add_u32 v8, s43, v8
  v_sub_u32 v9, 63, v1
  v_lshlrev_b32 v10, 2, v9
  v_add_u32 v10, s43, v10
  s_waitcnt lgkmcnt(6)
  v_mfma_f32_32x32x16_f16 v[48:63], v[160:163], v[164:167], v[48:63]
  v_sub_u32 v11, 31, v1
  v_and_b32 v11, 31, v11
  v_lshlrev_b32 v11, 3, v11
  v_add_u32 v11, s43, v11
  s_waitcnt lgkmcnt(4)
  v_mfma_f32_32x32x16_f16 v[48:63], v[168:171], v[172:175], v[48:63]
  v_and_b32 v9, 31, v9
  v_lshlrev_b32 v9, 4, v9
  v_sub_u32 v9, 496, v9
  v_add_u32 v9, s43, v9
  s_waitcnt lgkmcnt(2)
  v_mfma_f32_32x32x16_f16 v[48:63], v[176:179], v[180:183], v[48:63]
  v_lshlrev_b32 v3, 4, v1
  v_add_u32 v3, s76, v3
  s_waitcnt lgkmcnt(0)
  v_mfma_f32_32x32x16_f16 v[48:63], v[184:187], v[188:191], v[48:63]
  s_cmp_eq_u32 s50, 1
  s_cbranch_scc1 kg_tail_done
  s_mov_b32 s53, 0
  s_branch flg_3_chk
flg_3:
  s_mov_b64 exec, s[54:55]
  buffer_load_dwordx4 v[192:195], v196, s[8:11], s51 offen sc1
  s_mov_b64 exec, -1
flg_3_chk:
  s_waitcnt vmcnt(0)
  v_xor_b32 v192, s72, v192
  v_xor_b32 v193, s72, v193
  v_xor_b32 v194, s72, v194
  v_xor_b32 v195, s72, v195
  v_or3_b32 v197, v192, v193, v194
  v_or_b32 v197, v197, v195
  v_cmp_ne_u32 vcc, 0, v197
  s_and_b64 s[54:55], s[54:55], vcc
  s_cmp_eq_u64 s[54:55], 0
  s_cbranch_scc1 flg_3_done
  s_add_u32 s53, s53, 1
  s_sleep 1
  s_cmp_lt_u32 s53, 40000
  s_cbranch_scc1 flg_3
flg_3_done:
  v_lshrrev_b32 v216, 2, v1
  s_movk_i32 s52, 10240
  v_mul_lo_u32 v217, v216, s52
  v_and_b32 v218, 3, v1
  v_lshl_add_u32 v217, v218, 4, v217
  s_mul_i32 s52, s3, 655360
  s_lshl_b32 s53, s2, 6
  s_add_u32 s52, s52, s53
  s_add_u32 s52, s52, 0
  buffer_load_dwordx4 v[200:203], v217, s[8:11], s52 offen sc1
  s_add_u32 s52, s52, 163840
  buffer_load_dwordx4 v[204:207], v217, s[8:11], s52 offen sc1
  s_add_u32 s52, s52, 163840
  buffer_load_dwordx4 v[208:211], v217, s[8:11], s52 offen sc1
  s_add_u32 s52, s52, 163840
  buffer_load_dwordx4 v[212:215], v217, s[8:11], s52 offen sc1
  s_movk_i32 s52, 30432
  v_mul_lo_u32 v218, v218, s52
  v_lshl_add_u32 v218, v216, 4, v218
  s_lshl_b32 s52, s3, 10
  s_add_u32 s52, s52, 19744
  v_add_u32 v218, s52, v218
kg_tail_done:
  s_nop 7
  s_nop 3
  v_cvt_pk_f16_f32 v22, v51, v50
  v_cvt_pk_f16_f32 v23, v49, v48
  ds_write_b64 v17, v[22:23]
  v_cvt_pk_f16_f32 v24, v52, v53
  v_cvt_pk_f16_f32 v25, v54, v55
  ds_write_b32 v18, v24
  ds_write_b32 v19, v25
  v_cvt_pk_f16_f32 v26, v56, v57
  v_cvt_pk_f16_f32 v27, v58, v59
  ds_write_b64 v16, v[26:27]
  s_mov_b32 s44, 0x05040100
  s_mov_b32 s45, 0x01000100
  s_mov_b32 s46, 0x03020302
  s_mov_b32 s47, 0x07060100
  s_mov_b32 s48, 0x03020504
  v_and_b32 v7, 1, v4
  v_cmp_eq_u32 vcc, 1, v7
  s_waitcnt lgkmcnt(0)
  ds_read_u16 v32, v6 offset:1024
  ds_read_u16 v33, v8 offset:1024
  ds_read_u16 v34, v6 offset:1020
  ds_read_u16 v35, v8 offset:1020
  ds_read2_b32 v[36:37], v10 offset0:192 offset1:193
  ds_read_b64 v[38:39], v11 offset:512
  ds_read_u16 v40, v11 offset:520
  ds_read_b128 v[44:47], v9
  s_waitcnt lgkmcnt(4)
  v_cndmask_b32 v41, v32, v33, vcc
  v_cndmask_b32 v42, v34, v35, vcc
  v_perm_b32 v48, v33, v33, s45
  v_perm_b32 v49, v41, v33, s44
  v_perm_b32 v50, v32, v32, s45
  v_mov_b32 v51, v50
  ds_write_b128 v3, v[48:51]
  v_perm_b32 v52, v35, v35, s45
  v_perm_b32 v53, v42, v35, s44
  v_perm_b32 v54, v34, v34, s45
  v_mov_b32 v55, v54
  ds_write_b128 v3, v[52:55] offset:1024
  s_waitcnt lgkmcnt(2)
  v_perm_b32 v56, v37, v37, s45
  v_perm_b32 v57, v36, v36, s46
  v_alignbit_b32 v58, v36, v36, 16
  v_perm_b32 v59, v36, v36, s45
  ds_write_b128 v3, v[56:59] offset:2048
  v_perm_b32 v60, v39, v40, s47
  v_perm_b32 v61, v39, v39, s45
  v_perm_b32 v62, v39, v38, s48
  v_perm_b32 v63, v38, v38, s45
  v_cmp_gt_u32 vcc, 32, v1
  s_nop 1
  v_cndmask_b32 v60, v44, v60, vcc
  v_cndmask_b32 v61, v45, v61, vcc
  v_cndmask_b32 v62, v46, v62, vcc
  v_cndmask_b32 v63, v47, v63, vcc
  ds_write_b128 v3, v[60:63] offset:3072
  v_mov_b32 v16, 0
  v_mov_b32 v17, 0
  v_mov_b32 v18, 0
  v_mov_b32 v19, 0
  v_cmp_gt_u32 vcc, 30, v1
  s_and_saveexec_b64 s[52:53], vcc
  ds_write_b128 v3, v[16:19] offset:4096
  s_mov_b64 exec, s[52:53]
  v_lshlrev_b32 v9, 4, v1
  v_add_u32 v9, s75, v9
  v_add_u32 v10, 4096, v9
  v_cmp_gt_u32 vcc, 2, v1
  v_and_b32 v21, 15, v1
  v_lshrrev_b32 v22, 4, v1
  v_cndmask_b32 v10, v10, v9, vcc
  v_add_u32 v23, 1, v21
  v_and_b32 v24, 3, v23
  s_movk_i32 s53, 4160
  v_mul_lo_u32 v24, v24, s53
  v_lshrrev_b32 v23, 2, v23
  v_lshl_add_u32 v24, v23, 3, v24
  v_lshl_add_u32 v24, v22, 4, v24
  v_add_u32 v24, s75, v24
  v_lshlrev_b32 v25, 5, v21
  v_sub_u32 v25, 480, v25
  v_lshl_add_u32 v25, v22, 4, v25
  v_add_u32 v25, s76, v25
  v_lshlrev_b32 v26, 5, v21
  v_lshl_add_u32 v27, v22, 3, v26
  v_add_u32 v27, 32, v27
  v_add_u32 v27, s75, v27
  v_lshrrev_b32 v28, 1, v22
  v_lshl_add_u32 v26, v28, 4, v26
  v_and_b32 v28, 1, v22
  v_lshlrev_b32 v28, 30, v28
  v_or_b32 v26, v26, v28
  s_waitcnt lgkmcnt(0)
  s_barrier
  s_mov_b64 exec, 0xf
  ds_write_b128 v10, v[16:19]
  s_mov_b64 exec, -1
  s_waitcnt vmcnt(3)
  ds_write_b128 v218, v[200:203] offset:0
  s_waitcnt vmcnt(2)
  ds_write_b128 v218, v[204:207] offset:256
  s_waitcnt vmcnt(1)
  ds_write_b128 v218, v[208:211] offset:512
  s_waitcnt vmcnt(0)
  ds_write_b128 v218, v[212:215] offset:768
  v_mov_b32 v160, 0
  v_mov_b32 v161, 0
  v_mov_b32 v162, 0
  v_mov_b32 v163, 0
  s_waitcnt lgkmcnt(0)
  s_barrier
  ds_read_b128 v[128:131], v9 offset:32
  ds_read_b64 v[132:133], v9 offset:48
  ds_read_b128 v[136:139], v9 offset:1056
  ds_read_b64 v[140:141], v9 offset:1072
  ds_read_b128 v[144:147], v9 offset:2080
  ds_read_b64 v[148:149], v9 offset:2096
  ds_read_b128 v[152:155], v9 offset:3104
  ds_read_b64 v[156:157], v9 offset:3120
  ds_read_b64 v[164:165], v9 offset:16
  s_waitcnt lgkmcnt(7)
  v_alignbit_b32 v176, v129, v128, 16
  v_alignbit_b32 v177, v130, v129, 16
  v_alignbit_b32 v178, v131, v130, 16
  v_alignbit_b32 v179, v132, v131, 16
  ds_write_b128 v9, v[176:179] offset:4192
  v_mov_b32 v180, v129
  v_mov_b32 v181, v130
  v_mov_b32 v182, v131
  v_mov_b32 v183, v132
  ds_write_b128 v9, v[180:183] offset:8352
  v_mov_b32 v184, v177
  v_mov_b32 v185, v178
  v_mov_b32 v186, v179
  v_alignbit_b32 v187, v133, v132, 16
  ds_write_b128 v9, v[184:187] offset:12512
  s_waitcnt lgkmcnt(8)
  v_alignbit_b32 v188, v137, v136, 16
  v_alignbit_b32 v189, v138, v137, 16
  v_alignbit_b32 v190, v139, v138, 16
  v_alignbit_b32 v191, v140, v139, 16
  ds_write_b128 v9, v[188:191] offset:5216
  v_mov_b32 v192, v137
  v_mov_b32 v193, v138
  v_mov_b32 v194, v139
  v_mov_b32 v195, v140
  ds_write_b128 v9, v[192:195] offset:9376
  v_mov_b32 v196, v189
  v_mov_b32 v197, v190
  v_mov_b32 v198, v191
  v_alignbit_b32 v199, v141, v140, 16
  ds_write_b128 v9, v[196:199] offset:13536
  s_waitcnt lgkmcnt(9)
  v_alignbit_b32 v176, v145, v144, 16
  v_alignbit_b32 v177, v146, v145, 16
  v_alignbit_b32 v178, v147, v146, 16
  v_alignbit_b32 v179, v148, v147, 16
  ds_write_b128 v9, v[176:179] offset:6240
  v_mov_b32 v180, v145
  v_mov_b32 v181, v146
  v_mov_b32 v182, v147
  v_mov_b32 v183, v148
  ds_write_b128 v9, v[180:183] offset:10400
  v_mov_b32 v184, v177
  v_mov_b32 v185, v178
  v_mov_b32 v186, v179
  v_alignbit_b32 v187, v149, v148, 16
  ds_write_b128 v9, v[184:187] offset:14560
  s_waitcnt lgkmcnt(10)
  v_alignbit_b32 v188, v153, v152, 16
  v_alignbit_b32 v189, v154, v153, 16
  v_alignbit_b32 v190, v155, v154, 16
  v_alignbit_b32 v191, v156, v155, 16
  ds_write_b128 v9, v[188:191] offset:7264
  v_mov_b32 v192, v153
  v_mov_b32 v193, v154
  v_mov_b32 v194, v155
  v_mov_b32 v195, v156
  ds_write_b128 v9, v[192:195] offset:11424
  v_mov_b32 v196, v189
  v_mov_b32 v197, v190
  v_mov_b32 v198, v191
  v_alignbit_b32 v199, v157, v156, 16
  ds_write_b128 v9, v[196:199] offset:15584
  s_waitcnt lgkmcnt(12)
  v_alignbit_b32 v176, v161, v160, 16
  v_alignbit_b32 v177, v162, v161, 16
  v_alignbit_b32 v178, v163, v162, 16
  v_alignbit_b32 v179, v164, v163, 16
  s_mov_b64 exec, 3
  ds_write_b128 v9, v[176:179] offset:4160
  v_mov_b32 v180, v161
  v_mov_b32 v181, v162
  v_mov_b32 v182, v163
  v_mov_b32 v183, v164
  ds_write_b128 v9, v[180:183] offset:8320
  v_mov_b32 v184, v177
  v_mov_b32 v185, v178
  v_mov_b32 v186, v179
  v_alignbit_b32 v187, v165, v164, 16
  ds_write_b128 v9, v[184:187] offset:12480
  s_mov_b64 exec, -1
  s_waitcnt lgkmcnt(0)
  v_lshlrev_b32 v3, 12, v0
  s_lshl_b32 s43, s41, 1
  s_add_u32 s43, s43, 2621440
  s_add_u32 s44, s43, 1048576
  s_add_u32 s45, s43, 2097152
  s_mov_b64 s[54:55], -1
  s_mov_b64 s[56:57], -1
  s_mov_b64 s[58:59], -1
  ds_read_b64 v[64:65], v24 offset:0
  ds_read_b64 v[66:67], v24 offset:8
  ds_read_b128 a[28:31], v25 offset:3584
  ds_read_b128 a[60:63], v25 offset:3072
  ds_read_b128 a[92:95], v25 offset:2560
  ds_read_b128 a[124:127], v25 offset:2048
  ds_read_b128 a[156:159], v25 offset:1536
  ds_read_b128 a[188:191], v25 offset:1024
  ds_read_b128 a[220:223], v25 offset:512
  ds_read_b128 a[252:255], v25 offset:0
  ds_read_b64 v[68:69], v24 offset:64
  ds_read_b64 v[70:71], v24 offset:72
  ds_read_b128 a[24:27], v25 offset:3648
  ds_read_b128 a[56:59], v25 offset:3136
  s_waitcnt lgkmcnt(11)
  v_mfma_f32_16x16x32_f16 v[32:35], v[64:67], a[28:31], 0
  ds_read_b128 a[88:91], v25 offset:2624
  s_waitcnt lgkmcnt(11)
  v_mfma_f32_16x16x32_f16 v[36:39], v[64:67], a[60:63], 0
  ds_read_b128 a[120:123], v25 offset:2112
  s_waitcnt lgkmcnt(11)
  v_mfma_f32_16x16x32_f16 v[40:43], v[64:67], a[92:95], 0
  ds_read_b128 a[152:155], v25 offset:1600
  s_waitcnt lgkmcnt(11)
  v_mfma_f32_16x16x32_f16 v[44:47], v[64:67], a[124:127], 0
  ds_read_b128 a[184:187], v25 offset:1088
  s_waitcnt lgkmcnt(11)
  v_mfma_f32_16x16x32_f16 v[48:51], v[64:67], a[156:159], 0
  ds_read_b128 a[216:219], v25 offset:576
  s_waitcnt lgkmcnt(11)
  v_mfma_f32_16x16x32_f16 v[52:55], v[64:67], a[188:191], 0
  ds_read_b128 a[248:251], v25 offset:64
  s_waitcnt lgkmcnt(6)
  v_mfma_f32_16x16x32_f16 v[56:59], v[64:67], a[220:223], 0
  ds_read_b64 v[72:73], v24 offset:128
  ds_read_b64 v[74:75], v24 offset:136
  v_mfma_f32_16x16x32_f16 v[60:63], v[64:67], a[252:255], 0
  ds_read_b128 a[20:23], v25 offset:3712
  ds_read_b128 a[52:55], v25 offset:3200
  v_mfma_f32_16x16x32_f16 v[32:35], v[68:71], a[24:27], v[32:35]
  ds_read_b128 a[84:87], v25 offset:2688
  ds_read_b128 a[116:119], v25 offset:2176
  v_mfma_f32_16x16x32_f16 v[36:39], v[68:71], a[56:59], v[36:39]
  ds_read_b128 a[148:151], v25 offset:1664
  s_waitcnt lgkmcnt(9)
  v_mfma_f32_16x16x32_f16 v[40:43], v[68:71], a[88:91], v[40:43]
  ds_read_b128 a[180:183], v25 offset:1152
  ds_read_b128 a[212:215], v25 offset:640
  v_mfma_f32_16x16x32_f16 v[44:47], v[68:71], a[120:123], v[44:47]
  ds_read_b128 a[244:247], v25 offset:128
  ds_read_b64 v[76:77], v24 offset:192
  ds_read_b64 v[78:79], v24 offset:200
  v_mfma_f32_16x16x32_f16 v[48:51], v[68:71], a[152:155], v[48:51]
  v_mfma_f32_16x16x32_f16 v[52:55], v[68:71], a[184:187], v[52:55]
  s_waitcnt lgkmcnt(8)
  v_mfma_f32_16x16x32_f16 v[56:59], v[68:71], a[216:219], v[56:59]
  ds_read_b128 a[16:19], v25 offset:3776
  ds_read_b128 a[48:51], v25 offset:3264
  v_mfma_f32_16x16x32_f16 v[60:63], v[68:71], a[248:251], v[60:63]
  ds_read_b128 a[80:83], v25 offset:2752
  ds_read_b128 a[112:115], v25 offset:2240
  v_mfma_f32_16x16x32_f16 v[32:35], v[72:75], a[20:23], v[32:35]
  ds_read_b128 a[144:147], v25 offset:1728
  ds_read_b128 a[176:179], v25 offset:1216
  v_mfma_f32_16x16x32_f16 v[36:39], v[72:75], a[52:55], v[36:39]
  s_waitcnt lgkmcnt(6)
  v_mfma_f32_16x16x32_f16 v[40:43], v[72:75], a[84:87], v[40:43]
  ds_read_b128 a[208:211], v25 offset:704
  ds_read_b128 a[240:243], v25 offset:192
  v_mfma_f32_16x16x32_f16 v[44:47], v[72:75], a[116:119], v[44:47]
  ds_read_b64 v[80:81], v24 offset:256
  ds_read_b64 v[82:83], v24 offset:264
  v_mfma_f32_16x16x32_f16 v[48:51], v[72:75], a[148:151], v[48:51]
  ds_read_b128 a[12:15], v25 offset:3840
  ds_read_b128 a[44:47], v25 offset:3328
  v_mfma_f32_16x16x32_f16 v[52:55], v[72:75], a[180:183], v[52:55]
  ds_read_b128 a[76:79], v25 offset:2816
  v_mfma_f32_16x16x32_f16 v[56:59], v[72:75], a[212:215], v[56:59]
  ds_read_b128 a[108:111], v25 offset:2304
  v_mfma_f32_16x16x32_f16 v[60:63], v[72:75], a[244:247], v[60:63]
  s_waitcnt lgkmcnt(8)
  v_mfma_f32_16x16x32_f16 v[32:35], v[76:79], a[16:19], v[32:35]
  ds_read_b128 a[140:143], v25 offset:1792
  ds_read_b128 a[172:175], v25 offset:1280
  v_mfma_f32_16x16x32_f16 v[36:39], v[76:79], a[48:51], v[36:39]
  ds_read_b128 a[204:207], v25 offset:768
  v_mfma_f32_16x16x32_f16 v[40:43], v[76:79], a[80:83], v[40:43]
  ds_read_b128 a[236:239], v25 offset:256
  v_mfma_f32_16x16x32_f16 v[44:47], v[76:79], a[112:115], v[44:47]
  ds_read_b64 v[84:85], v24 offset:320
  ds_read_b64 v[86:87], v24 offset:328
  v_mfma_f32_16x16x32_f16 v[48:51], v[76:79], a[144:147], v[48:51]
  v_mfma_f32_16x16x32_f16 v[52:55], v[76:79], a[176:179], v[52:55]
  s_waitcnt lgkmcnt(6)
  v_mfma_f32_16x16x32_f16 v[56:59], v[76:79], a[208:211], v[56:59]
  ds_read_b128 a[8:11], v25 offset:3904
  ds_read_b128 a[40:43], v25 offset:3392
  v_mfma_f32_16x16x32_f16 v[60:63], v[76:79], a[240:243], v[60:63]
  ds_read_b128 a[72:75], v25 offset:2880
  ds_read_b128 a[104:107], v25 offset:2368
  v_mfma_f32_16x16x32_f16 v[32:35], v[80:83], a[12:15], v[32:35]
  ds_read_b128 a[136:139], v25 offset:1856
  ds_read_b128 a[168:171], v25 offset:1344
  v_mfma_f32_16x16x32_f16 v[36:39], v[80:83], a[44:47], v[36:39]
  ds_read_b128 a[200:203], v25 offset:832
  v_mfma_f32_16x16x32_f16 v[40:43], v[80:83], a[76:79], v[40:43]
  ds_read_b128 a[232:235], v25 offset:320
  v_mfma_f32_16x16x32_f16 v[44:47], v[80:83], a[108:111], v[44:47]
  s_waitcnt lgkmcnt(8)
  v_mfma_f32_16x16x32_f16 v[48:51], v[80:83], a[140:143], v[48:51]
  ds_read_b64 v[88:89], v24 offset:384
  ds_read_b64 v[90:91], v24 offset:392
  v_mfma_f32_16x16x32_f16 v[52:55], v[80:83], a[172:175], v[52:55]
  ds_read_b128 a[4:7], v25 offset:3968
  ds_read_b128 a[36:39], v25 offset:3456
  v_mfma_f32_16x16x32_f16 v[56:59], v[80:83], a[204:207], v[56:59]
  ds_read_b128 a[68:71], v25 offset:2944
  ds_read_b128 a[100:103], v25 offset:2432
  v_mfma_f32_16x16x32_f16 v[60:63], v[80:83], a[236:239], v[60:63]
  s_waitcnt lgkmcnt(7)
  v_mfma_f32_16x16x32_f16 v[32:35], v[84:87], a[8:11], v[32:35]
  ds_read_b128 a[132:135], v25 offset:1920
  ds_read_b128 a[164:167], v25 offset:1408
  v_mfma_f32_16x16x32_f16 v[36:39], v[84:87], a[40:43], v[36:39]
  ds_read_b128 a[196:199], v25 offset:896
  v_mfma_f32_16x16x32_f16 v[40:43], v[84:87], a[72:75], v[40:43]
  ds_read_b128 a[228:231], v25 offset:384
  v_mfma_f32_16x16x32_f16 v[44:47], v[84:87], a[104:107], v[44:47]
  ds_read_b64 v[92:93], v24 offset:448
  ds_read_b64 v[94:95], v24 offset:456
  v_mfma_f32_16x16x32_f16 v[48:51], v[84:87], a[136:139], v[48:51]
  ds_read_b128 a[0:3], v25 offset:4032
  v_mfma_f32_16x16x32_f16 v[52:55], v[84:87], a[168:171], v[52:55]
  v_mfma_f32_16x16x32_f16 v[56:59], v[84:87], a[200:203], v[56:59]
  s_waitcnt lgkmcnt(5)
  v_mfma_f32_16x16x32_f16 v[60:63], v[84:87], a[232:235], v[60:63]
  ds_read_b128 a[32:35], v25 offset:3520
  ds_read_b128 a[64:67], v25 offset:3008
  v_mfma_f32_16x16x32_f16 v[32:35], v[88:91], a[4:7], v[32:35]
  ds_read_b128 a[96:99], v25 offset:2496
  ds_read_b128 a[128:131], v25 offset:1984
  v_mfma_f32_16x16x32_f16 v[36:39], v[88:91], a[36:39], v[36:39]
  ds_read_b128 a[160:163], v25 offset:1472
  ds_read_b128 a[192:195], v25 offset:960
  v_mfma_f32_16x16x32_f16 v[40:43], v[88:91], a[68:71], v[40:43]
  ds_read_b128 a[224:227], v25 offset:448
  v_mfma_f32_16x16x32_f16 v[44:47], v[88:91], a[100:103], v[44:47]
  ds_read_b64 v[96:97], v24 offset:512
  ds_read_b64 v[98:99], v24 offset:520
  v_mfma_f32_16x16x32_f16 v[48:51], v[88:91], a[132:135], v[48:51]
  v_mfma_f32_16x16x32_f16 v[52:55], v[88:91], a[164:167], v[52:55]
  s_waitcnt lgkmcnt(7)
  v_mfma_f32_16x16x32_f16 v[56:59], v[88:91], a[196:199], v[56:59]
  v_mfma_f32_16x16x32_f16 v[60:63], v[88:91], a[228:231], v[60:63]
  v_mfma_f32_16x16x32_f16 v[32:35], v[92:95], a[0:3], v[32:35]
  ds_read_b64 v[126:127], v27 offset:0
  v_mfma_f32_16x16x32_f16 v[36:39], v[92:95], a[32:35], v[36:39]
  v_mfma_f32_16x16x32_f16 v[40:43], v[92:95], a[64:67], v[40:43]
  ds_read_b64 v[100:101], v24 offset:576
  ds_read_b64 v[102:103], v24 offset:584
  s_waitcnt lgkmcnt(3)
  v_mfma_f32_16x16x32_f16 v[44:47], v[92:95], a[96:99], v[44:47]
  v_mfma_f32_16x16x32_f16 v[48:51], v[92:95], a[128:131], v[48:51]
  v_mfma_f32_16x16x32_f16 v[52:55], v[92:95], a[160:163], v[52:55]
  v_mfma_f32_16x16x32_f16 v[56:59], v[92:95], a[192:195], v[56:59]
  v_mfma_f32_16x16x32_f16 v[60:63], v[92:95], a[224:227], v[60:63]
  v_cvt_pk_bf16_f32 v112, 0, v32
  v_cvt_pk_bf16_f32 v113, 0, v33
  v_mfma_f32_16x16x32_f16 v[36:39], v[96:99], a[28:31], v[36:39]
  v_cvt_pk_bf16_f32 v114, 0, v34
  v_cvt_pk_bf16_f32 v115, 0, v35
  v_mfma_f32_16x16x32_f16 v[40:43], v[96:99], a[60:63], v[40:43]
  ds_read_b64 v[104:105], v24 offset:640
  ds_read_b64 v[106:107], v24 offset:648
  v_mfma_f32_16x16x32_f16 v[44:47], v[96:99], a[92:95], v[44:47]
  s_waitcnt lgkmcnt(2)
  v_fma_mix_f32 v116, v126, s79, 0 op_sel_hi:[1,0,0]
  v_mfma_f32_16x16x32_f16 v[48:51], v[96:99], a[124:127], v[48:51]
  v_fma_mix_f32 v117, v126, s79, 0 op_sel:[1,0,0] op_sel_hi:[1,0,0]
  v_fma_mix_f32 v118, v127, s79, 0 op_sel_hi:[1,0,0]
  v_mfma_f32_16x16x32_f16 v[52:55], v[96:99], a[156:159], v[52:55]
  v_fma_mix_f32 v119, v127, s79, 0 op_sel:[1,0,0] op_sel_hi:[1,0,0]
  v_cvt_pk_bf16_f32 v116, 0, v116
  v_mfma_f32_16x16x32_f16 v[56:59], v[96:99], a[188:191], v[56:59]
  v_cvt_pk_bf16_f32 v117, 0, v117
  v_cvt_pk_bf16_f32 v118, 0, v118
  v_mfma_f32_16x16x32_f16 v[60:63], v[96:99], a[220:223], v[60:63]
  v_cvt_pk_bf16_f32 v119, 0, v119
  v_fmac_f32 v116, v30, v112
  v_mfma_f32_16x16x32_f16 v[36:39], v[100:103], a[24:27], v[36:39]
  v_fmac_f32 v117, v30, v113
  v_fmac_f32 v118, v30, v114
  v_mfma_f32_16x16x32_f16 v[40:43], v[100:103], a[56:59], v[40:43]
  ds_read_b64 v[108:109], v24 offset:704
  ds_read_b64 v[110:111], v24 offset:712
  v_mfma_f32_16x16x32_f16 v[44:47], v[100:103], a[88:91], v[44:47]
  v_fmac_f32 v119, v30, v115
  v_cvt_pk_bf16_f32 v112, v116, v117
  v_mfma_f32_16x16x32_f16 v[48:51], v[100:103], a[120:123], v[48:51]
  v_cvt_pk_bf16_f32 v113, v118, v119
  v_mfma_f32_16x16x32_f16 v[52:55], v[100:103], a[152:155], v[52:55]
  v_mfma_f32_16x16x32_f16 v[56:59], v[100:103], a[184:187], v[56:59]
  v_permlane16_swap_b32 v112, v114
  v_permlane16_swap_b32 v113, v115
  v_mfma_f32_16x16x32_f16 v[60:63], v[100:103], a[216:219], v[60:63]
  buffer_store_dwordx4 v[112:115], v26, s[8:11], s77 offen offset:0 sc1
  s_waitcnt lgkmcnt(2)
  v_mfma_f32_16x16x32_f16 v[36:39], v[104:107], a[20:23], v[36:39]
  v_mfma_f32_16x16x32_f16 v[40:43], v[104:107], a[52:55], v[40:43]
  ds_read_b64 v[64:65], v24 offset:768
  ds_read_b64 v[66:67], v24 offset:776
  v_mfma_f32_16x16x32_f16 v[44:47], v[104:107], a[84:87], v[44:47]
  v_mfma_f32_16x16x32_f16 v[48:51], v[104:107], a[116:119], v[48:51]
  v_mfma_f32_16x16x32_f16 v[52:55], v[104:107], a[148:151], v[52:55]
  v_mfma_f32_16x16x32_f16 v[56:59], v[104:107], a[180:183], v[56:59]
  v_mfma_f32_16x16x32_f16 v[60:63], v[104:107], a[212:215], v[60:63]
  s_waitcnt lgkmcnt(2)
  v_mfma_f32_16x16x32_f16 v[36:39], v[108:111], a[16:19], v[36:39]
  v_mfma_f32_16x16x32_f16 v[40:43], v[108:111], a[48:51], v[40:43]
  ds_read_b64 v[68:69], v24 offset:832
  ds_read_b64 v[70:71], v24 offset:840
  v_mfma_f32_16x16x32_f16 v[44:47], v[108:111], a[80:83], v[44:47]
  v_mfma_f32_16x16x32_f16 v[48:51], v[108:111], a[112:115], v[48:51]
  v_mfma_f32_16x16x32_f16 v[52:55], v[108:111], a[144:147], v[52:55]
  v_mfma_f32_16x16x32_f16 v[56:59], v[108:111], a[176:179], v[56:59]
  v_mfma_f32_16x16x32_f16 v[60:63], v[108:111], a[208:211], v[60:63]
  s_waitcnt lgkmcnt(2)
  v_mfma_f32_16x16x32_f16 v[36:39], v[64:67], a[12:15], v[36:39]
  v_mfma_f32_16x16x32_f16 v[40:43], v[64:67], a[44:47], v[40:43]
  ds_read_b64 v[72:73], v24 offset:896
  ds_read_b64 v[74:75], v24 offset:904
  v_mfma_f32_16x16x32_f16 v[44:47], v[64:67], a[76:79], v[44:47]
  v_mfma_f32_16x16x32_f16 v[48:51], v[64:67], a[108:111], v[48:51]
  v_mfma_f32_16x16x32_f16 v[52:55], v[64:67], a[140:143], v[52:55]
  v_mfma_f32_16x16x32_f16 v[56:59], v[64:67], a[172:175], v[56:59]
  v_mfma_f32_16x16x32_f16 v[60:63], v[64:67], a[204:207], v[60:63]
  s_waitcnt lgkmcnt(2)
  v_mfma_f32_16x16x32_f16 v[36:39], v[68:71], a[8:11], v[36:39]
  v_mfma_f32_16x16x32_f16 v[40:43], v[68:71], a[40:43], v[40:43]
  ds_read_b64 v[76:77], v24 offset:960
  ds_read_b64 v[78:79], v24 offset:968
  v_mfma_f32_16x16x32_f16 v[44:47], v[68:71], a[72:75], v[44:47]
  v_mfma_f32_16x16x32_f16 v[48:51], v[68:71], a[104:107], v[48:51]
  v_mfma_f32_16x16x32_f16 v[52:55], v[68:71], a[136:139], v[52:55]
  v_mfma_f32_16x16x32_f16 v[56:59], v[68:71], a[168:171], v[56:59]
  v_mfma_f32_16x16x32_f16 v[60:63], v[68:71], a[200:203], v[60:63]
  s_waitcnt lgkmcnt(2)
  v_mfma_f32_16x16x32_f16 v[36:39], v[72:75], a[4:7], v[36:39]
  v_mfma_f32_16x16x32_f16 v[40:43], v[72:75], a[36:39], v[40:43]
  ds_read_b64 v[80:81], v24 offset:1024
  ds_read_b64 v[82:83], v24 offset:1032
  v_mfma_f32_16x16x32_f16 v[44:47], v[72:75], a[68:71], v[44:47]
  v_mfma_f32_16x16x32_f16 v[48:51], v[72:75], a[100:103], v[48:51]
  v_mfma_f32_16x16x32_f16 v[52:55], v[72:75], a[132:135], v[52:55]
  v_mfma_f32_16x16x32_f16 v[56:59], v[72:75], a[164:167], v[56:59]
  v_mfma_f32_16x16x32_f16 v[60:63], v[72:75], a[196:199], v[60:63]
  s_waitcnt lgkmcnt(2)
  v_mfma_f32_16x16x32_f16 v[36:39], v[76:79], a[0:3], v[36:39]
  ds_read_b64 v[84:85], v24 offset:1088
  ds_read_b64 v[86:87], v24 offset:1096
  v_mfma_f32_16x16x32_f16 v[40:43], v[76:79], a[32:35], v[40:43]
  ds_read_b64 v[142:143], v27 offset:512
  v_mfma_f32_16x16x32_f16 v[44:47], v[76:79], a[64:67], v[44:47]
  v_mfma_f32_16x16x32_f16 v[48:51], v[76:79], a[96:99], v[48:51]
  v_mfma_f32_16x16x32_f16 v[52:55], v[76:79], a[128:131], v[52:55]
  v_mfma_f32_16x16x32_f16 v[56:59], v[76:79], a[160:163], v[56:59]
  v_mfma_f32_16x16x32_f16 v[60:63], v[76:79], a[192:195], v[60:63]
  ds_read_b64 v[88:89], v24 offset:1152
  ds_read_b64 v[90:91], v24 offset:1160
  s_waitcnt lgkmcnt(3)
  v_mfma_f32_16x16x32_f16 v[40:43], v[80:83], a[28:31], v[40:43]
  v_cvt_pk_bf16_f32 v128, 0, v36
  v_cvt_pk_bf16_f32 v129, 0, v37
  v_mfma_f32_16x16x32_f16 v[44:47], v[80:83], a[60:63], v[44:47]
  v_cvt_pk_bf16_f32 v130, 0, v38
  v_cvt_pk_bf16_f32 v131, 0, v39
  v_mfma_f32_16x16x32_f16 v[48:51], v[80:83], a[92:95], v[48:51]
  s_waitcnt lgkmcnt(2)
  v_fma_mix_f32 v132, v142, s79, 0 op_sel_hi:[1,0,0]
  v_mfma_f32_16x16x32_f16 v[52:55], v[80:83], a[124:127], v[52:55]
  v_fma_mix_f32 v133, v142, s79, 0 op_sel:[1,0,0] op_sel_hi:[1,0,0]
  v_fma_mix_f32 v134, v143, s79, 0 op_sel_hi:[1,0,0]
  v_mfma_f32_16x16x32_f16 v[56:59], v[80:83], a[156:159], v[56:59]
  v_fma_mix_f32 v135, v143, s79, 0 op_sel:[1,0,0] op_sel_hi:[1,0,0]
  v_cvt_pk_bf16_f32 v132, 0, v132
  v_mfma_f32_16x16x32_f16 v[60:63], v[80:83], a[188:191], v[60:63]
  ds_read_b64 v[92:93], v24 offset:1216
  ds_read_b64 v[94:95], v24 offset:1224
  v_mfma_f32_16x16x32_f16 v[40:43], v[84:87], a[24:27], v[40:43]
  v_cvt_pk_bf16_f32 v133, 0, v133
  v_cvt_pk_bf16_f32 v134, 0, v134
  v_mfma_f32_16x16x32_f16 v[44:47], v[84:87], a[56:59], v[44:47]
  v_cvt_pk_bf16_f32 v135, 0, v135
  v_fmac_f32 v132, v30, v128
  v_mfma_f32_16x16x32_f16 v[48:51], v[84:87], a[88:91], v[48:51]
  v_fmac_f32 v133, v30, v129
  v_fmac_f32 v134, v30, v130
  v_mfma_f32_16x16x32_f16 v[52:55], v[84:87], a[120:123], v[52:55]
  v_fmac_f32 v135, v30, v131
  v_cvt_pk_bf16_f32 v128, v132, v133
  v_mfma_f32_16x16x32_f16 v[56:59], v[84:87], a[152:155], v[56:59]
  v_cvt_pk_bf16_f32 v129, v134, v135
  v_mfma_f32_16x16x32_f16 v[60:63], v[84:87], a[184:187], v[60:63]
  ds_read_b64 v[96:97], v24 offset:1280
  ds_read_b64 v[98:99], v24 offset:1288
  s_waitcnt lgkmcnt(2)
  v_mfma_f32_16x16x32_f16 v[40:43], v[88:91], a[20:23], v[40:43]
  v_permlane16_swap_b32 v128, v130
  v_permlane16_swap_b32 v129, v131
  v_mfma_f32_16x16x32_f16 v[44:47], v[88:91], a[52:55], v[44:47]
  buffer_store_dwordx4 v[128:131], v26, s[8:11], s77 offen offset:512 sc1
  v_mfma_f32_16x16x32_f16 v[48:51], v[88:91], a[84:87], v[48:51]
  v_mfma_f32_16x16x32_f16 v[52:55], v[88:91], a[116:119], v[52:55]
  v_mfma_f32_16x16x32_f16 v[56:59], v[88:91], a[148:151], v[56:59]
  v_mfma_f32_16x16x32_f16 v[60:63], v[88:91], a[180:183], v[60:63]
  ds_read_b64 v[100:101], v24 offset:1344
  ds_read_b64 v[102:103], v24 offset:1352
  v_mfma_f32_16x16x32_f16 v[40:43], v[92:95], a[16:19], v[40:43]
  v_mfma_f32_16x16x32_f16 v[44:47], v[92:95], a[48:51], v[44:47]
  v_mfma_f32_16x16x32_f16 v[48:51], v[92:95], a[80:83], v[48:51]
  v_mfma_f32_16x16x32_f16 v[52:55], v[92:95], a[112:115], v[52:55]
  v_mfma_f32_16x16x32_f16 v[56:59], v[92:95], a[144:147], v[56:59]
  v_mfma_f32_16x16x32_f16 v[60:63], v[92:95], a[176:179], v[60:63]
  ds_read_b64 v[104:105], v24 offset:1408
  ds_read_b64 v[106:107], v24 offset:1416
  s_waitcnt lgkmcnt(2)
  v_mfma_f32_16x16x32_f16 v[40:43], v[96:99], a[12:15], v[40:43]
  v_mfma_f32_16x16x32_f16 v[44:47], v[96:99], a[44:47], v[44:47]
  v_mfma_f32_16x16x32_f16 v[48:51], v[96:99], a[76:79], v[48:51]
  v_mfma_f32_16x16x32_f16 v[52:55], v[96:99], a[108:111], v[52:55]
  v_mfma_f32_16x16x32_f16 v[56:59], v[96:99], a[140:143], v[56:59]
  v_mfma_f32_16x16x32_f16 v[60:63], v[96:99], a[172:175], v[60:63]
  ds_read_b64 v[108:109], v24 offset:1472
  ds_read_b64 v[110:111], v24 offset:1480
  v_mfma_f32_16x16x32_f16 v[40:43], v[100:103], a[8:11], v[40:43]
  v_mfma_f32_16x16x32_f16 v[44:47], v[100:103], a[40:43], v[44:47]
  v_mfma_f32_16x16x32_f16 v[48:51], v[100:103], a[72:75], v[48:51]
  v_mfma_f32_16x16x32_f16 v[52:55], v[100:103], a[104:107], v[52:55]
  v_mfma_f32_16x16x32_f16 v[56:59], v[100:103], a[136:139], v[56:59]
  v_mfma_f32_16x16x32_f16 v[60:63], v[100:103], a[168:171], v[60:63]
  ds_read_b64 v[64:65], v24 offset:1536
  ds_read_b64 v[66:67], v24 offset:1544
  s_waitcnt lgkmcnt(2)
  v_mfma_f32_16x16x32_f16 v[40:43], v[104:107], a[4:7], v[40:43]
  v_mfma_f32_16x16x32_f16 v[44:47], v[104:107], a[36:39], v[44:47]
  v_mfma_f32_16x16x32_f16 v[48:51], v[104:107], a[68:71], v[48:51]
  v_mfma_f32_16x16x32_f16 v[52:55], v[104:107], a[100:103], v[52:55]
  v_mfma_f32_16x16x32_f16 v[56:59], v[104:107], a[132:135], v[56:59]
  ds_read_b64 v[68:69], v24 offset:1600
  ds_read_b64 v[70:71], v24 offset:1608
  v_mfma_f32_16x16x32_f16 v[60:63], v[104:107], a[164:167], v[60:63]
  v_mfma_f32_16x16x32_f16 v[40:43], v[108:111], a[0:3], v[40:43]
  ds_read_b64 v[126:127], v27 offset:1024
  v_mfma_f32_16x16x32_f16 v[44:47], v[108:111], a[32:35], v[44:47]
  v_mfma_f32_16x16x32_f16 v[48:51], v[108:111], a[64:67], v[48:51]
  v_mfma_f32_16x16x32_f16 v[52:55], v[108:111], a[96:99], v[52:55]
  ds_read_b64 v[72:73], v24 offset:1664
  ds_read_b64 v[74:75], v24 offset:1672
  v_mfma_f32_16x16x32_f16 v[56:59], v[108:111], a[128:131], v[56:59]
  v_mfma_f32_16x16x32_f16 v[60:63], v[108:111], a[160:163], v[60:63]
  s_waitcnt lgkmcnt(3)
  v_mfma_f32_16x16x32_f16 v[44:47], v[64:67], a[28:31], v[44:47]
  v_mfma_f32_16x16x32_f16 v[48:51], v[64:67], a[60:63], v[48:51]
  v_cvt_pk_bf16_f32 v112, 0, v40
  v_cvt_pk_bf16_f32 v113, 0, v41
  v_mfma_f32_16x16x32_f16 v[52:55], v[64:67], a[92:95], v[52:55]
  ds_read_b64 v[76:77], v24 offset:1728
  ds_read_b64 v[78:79], v24 offset:1736
  v_mfma_f32_16x16x32_f16 v[56:59], v[64:67], a[124:127], v[56:59]
  v_cvt_pk_bf16_f32 v114, 0, v42
  v_cvt_pk_bf16_f32 v115, 0, v43
  v_mfma_f32_16x16x32_f16 v[60:63], v[64:67], a[156:159], v[60:63]
  s_waitcnt lgkmcnt(2)
  v_fma_mix_f32 v116, v126, s79, 0 op_sel_hi:[1,0,0]
  v_mfma_f32_16x16x32_f16 v[44:47], v[68:71], a[24:27], v[44:47]
  v_fma_mix_f32 v117, v126, s79, 0 op_sel:[1,0,0] op_sel_hi:[1,0,0]
  v_fma_mix_f32 v118, v127, s79, 0 op_sel_hi:[1,0,0]
  v_mfma_f32_16x16x32_f16 v[48:51], v[68:71], a[56:59], v[48:51]
  v_fma_mix_f32 v119, v127, s79, 0 op_sel:[1,0,0] op_sel_hi:[1,0,0]
  v_cvt_pk_bf16_f32 v116, 0, v116
  v_mfma_f32_16x16x32_f16 v[52:55], v[68:71], a[88:91], v[52:55]
  ds_read_b64 v[80:81], v24 offset:1792
  ds_read_b64 v[82:83], v24 offset:1800
  v_mfma_f32_16x16x32_f16 v[56:59], v[68:71], a[120:123], v[56:59]
  v_cvt_pk_bf16_f32 v117, 0, v117
  v_cvt_pk_bf16_f32 v118, 0, v118
  v_mfma_f32_16x16x32_f16 v[60:63], v[68:71], a[152:155], v[60:63]
  v_cvt_pk_bf16_f32 v119, 0, v119
  v_fmac_f32 v116, v30, v112
  v_mfma_f32_16x16x32_f16 v[44:47], v[72:75], a[20:23], v[44:47]
  v_fmac_f32 v117, v30, v113
  v_fmac_f32 v118, v30, v114
  v_mfma_f32_16x16x32_f16 v[48:51], v[72:75], a[52:55], v[48:51]
  v_fmac_f32 v119, v30, v115
  v_cvt_pk_bf16_f32 v112, v116, v117
  v_mfma_f32_16x16x32_f16 v[52:55], v[72:75], a[84:87], v[52:55]
  ds_read_b64 v[84:85], v24 offset:1856
  ds_read_b64 v[86:87], v24 offset:1864
  v_mfma_f32_16x16x32_f16 v[56:59], v[72:75], a[116:119], v[56:59]
  v_cvt_pk_bf16_f32 v113, v118, v119
  v_mfma_f32_16x16x32_f16 v[60:63], v[72:75], a[148:151], v[60:63]
  s_waitcnt lgkmcnt(2)
  v_mfma_f32_16x16x32_f16 v[44:47], v[76:79], a[16:19], v[44:47]
  v_permlane16_swap_b32 v112, v114
  v_permlane16_swap_b32 v113, v115
  v_mfma_f32_16x16x32_f16 v[48:51], v[76:79], a[48:51], v[48:51]
  buffer_store_dwordx4 v[112:115], v26, s[8:11], s77 offen offset:1024 sc1
  v_mfma_f32_16x16x32_f16 v[52:55], v[76:79], a[80:83], v[52:55]
  ds_read_b64 v[88:89], v24 offset:1920
  ds_read_b64 v[90:91], v24 offset:1928
  v_mfma_f32_16x16x32_f16 v[56:59], v[76:79], a[112:115], v[56:59]
  v_mfma_f32_16x16x32_f16 v[60:63], v[76:79], a[144:147], v[60:63]
  v_mfma_f32_16x16x32_f16 v[44:47], v[80:83], a[12:15], v[44:47]
  v_mfma_f32_16x16x32_f16 v[48:51], v[80:83], a[44:47], v[48:51]
  v_mfma_f32_16x16x32_f16 v[52:55], v[80:83], a[76:79], v[52:55]
  ds_read_b64 v[92:93], v24 offset:1984
  ds_read_b64 v[94:95], v24 offset:1992
  v_mfma_f32_16x16x32_f16 v[56:59], v[80:83], a[108:111], v[56:59]
  v_mfma_f32_16x16x32_f16 v[60:63], v[80:83], a[140:143], v[60:63]
  s_waitcnt lgkmcnt(2)
  v_mfma_f32_16x16x32_f16 v[44:47], v[84:87], a[8:11], v[44:47]
  v_mfma_f32_16x16x32_f16 v[48:51], v[84:87], a[40:43], v[48:51]
  v_mfma_f32_16x16x32_f16 v[52:55], v[84:87], a[72:75], v[52:55]
  ds_read_b64 v[96:97], v24 offset:2048
  ds_read_b64 v[98:99], v24 offset:2056
  v_mfma_f32_16x16x32_f16 v[56:59], v[84:87], a[104:107], v[56:59]
  v_mfma_f32_16x16x32_f16 v[60:63], v[84:87], a[136:139], v[60:63]
  v_mfma_f32_16x16x32_f16 v[44:47], v[88:91], a[4:7], v[44:47]
  v_mfma_f32_16x16x32_f16 v[48:51], v[88:91], a[36:39], v[48:51]
  ds_read_b64 v[100:101], v24 offset:2112
  ds_read_b64 v[102:103], v24 offset:2120
  v_mfma_f32_16x16x32_f16 v[52:55], v[88:91], a[68:71], v[52:55]
  v_mfma_f32_16x16x32_f16 v[56:59], v[88:91], a[100:103], v[56:59]
  v_mfma_f32_16x16x32_f16 v[60:63], v[88:91], a[132:135], v[60:63]
  s_waitcnt lgkmcnt(2)
  v_mfma_f32_16x16x32_f16 v[44:47], v[92:95], a[0:3], v[44:47]
  ds_read_b64 v[104:105], v24 offset:2176
  ds_read_b64 v[106:107], v24 offset:2184
  v_mfma_f32_16x16x32_f16 v[48:51], v[92:95], a[32:35], v[48:51]
  ds_read_b64 v[142:143], v27 offset:1536
  v_mfma_f32_16x16x32_f16 v[52:55], v[92:95], a[64:67], v[52:55]
  v_mfma_f32_16x16x32_f16 v[56:59], v[92:95], a[96:99], v[56:59]
  v_mfma_f32_16x16x32_f16 v[60:63], v[92:95], a[128:131], v[60:63]
  ds_read_b64 v[108:109], v24 offset:2240
  ds_read_b64 v[110:111], v24 offset:2248
  v_mfma_f32_16x16x32_f16 v[48:51], v[96:99], a[28:31], v[48:51]
  v_mfma_f32_16x16x32_f16 v[52:55], v[96:99], a[60:63], v[52:55]
  v_mfma_f32_16x16x32_f16 v[56:59], v[96:99], a[92:95], v[56:59]
  v_cvt_pk_bf16_f32 v128, 0, v44
  v_cvt_pk_bf16_f32 v129, 0, v45
  v_mfma_f32_16x16x32_f16 v[60:63], v[96:99], a[124:127], v[60:63]
  ds_read_b64 v[64:65], v24 offset:2304
  ds_read_b64 v[66:67], v24 offset:2312
  s_waitcnt lgkmcnt(4)
  v_mfma_f32_16x16x32_f16 v[48:51], v[100:103], a[24:27], v[48:51]
  v_cvt_pk_bf16_f32 v130, 0, v46
  v_cvt_pk_bf16_f32 v131, 0, v47
  v_mfma_f32_16x16x32_f16 v[52:55], v[100:103], a[56:59], v[52:55]
  v_fma_mix_f32 v132, v142, s79, 0 op_sel_hi:[1,0,0]
  v_fma_mix_f32 v133, v142, s79, 0 op_sel:[1,0,0] op_sel_hi:[1,0,0]
  v_mfma_f32_16x16x32_f16 v[56:59], v[100:103], a[88:91], v[56:59]
  v_fma_mix_f32 v134, v143, s79, 0 op_sel_hi:[1,0,0]
  v_fma_mix_f32 v135, v143, s79, 0 op_sel:[1,0,0] op_sel_hi:[1,0,0]
  v_mfma_f32_16x16x32_f16 v[60:63], v[100:103], a[120:123], v[60:63]
  ds_read_b64 v[68:69], v24 offset:2368
  ds_read_b64 v[70:71], v24 offset:2376
  v_mfma_f32_16x16x32_f16 v[48:51], v[104:107], a[20:23], v[48:51]
  v_cvt_pk_bf16_f32 v132, 0, v132
  v_cvt_pk_bf16_f32 v133, 0, v133
  v_mfma_f32_16x16x32_f16 v[52:55], v[104:107], a[52:55], v[52:55]
  v_cvt_pk_bf16_f32 v134, 0, v134
  v_cvt_pk_bf16_f32 v135, 0, v135
  v_mfma_f32_16x16x32_f16 v[56:59], v[104:107], a[84:87], v[56:59]
  v_fmac_f32 v132, v30, v128
  v_fmac_f32 v133, v30, v129
  v_mfma_f32_16x16x32_f16 v[60:63], v[104:107], a[116:119], v[60:63]
  ds_read_b64 v[72:73], v24 offset:2432
  ds_read_b64 v[74:75], v24 offset:2440
  s_waitcnt lgkmcnt(4)
  v_mfma_f32_16x16x32_f16 v[48:51], v[108:111], a[16:19], v[48:51]
  v_fmac_f32 v134, v30, v130
  v_fmac_f32 v135, v30, v131
  v_mfma_f32_16x16x32_f16 v[52:55], v[108:111], a[48:51], v[52:55]
  v_cvt_pk_bf16_f32 v128, v132, v133
  v_cvt_pk_bf16_f32 v129, v134, v135
  v_mfma_f32_16x16x32_f16 v[56:59], v[108:111], a[80:83], v[56:59]
  v_mfma_f32_16x16x32_f16 v[60:63], v[108:111], a[112:115], v[60:63]
  ds_read_b64 v[76:77], v24 offset:2496
  ds_read_b64 v[78:79], v24 offset:2504
  v_mfma_f32_16x16x32_f16 v[48:51], v[64:67], a[12:15], v[48:51]
  v_permlane16_swap_b32 v128, v130
  v_permlane16_swap_b32 v129, v131
  v_mfma_f32_16x16x32_f16 v[52:55], v[64:67], a[44:47], v[52:55]
  buffer_store_dwordx4 v[128:131], v26, s[8:11], s77 offen offset:1536 sc1
  v_mfma_f32_16x16x32_f16 v[56:59], v[64:67], a[76:79], v[56:59]
  v_mfma_f32_16x16x32_f16 v[60:63], v[64:67], a[108:111], v[60:63]
  ds_read_b64 v[80:81], v24 offset:2560
  ds_read_b64 v[82:83], v24 offset:2568
  s_waitcnt lgkmcnt(4)
  v_mfma_f32_16x16x32_f16 v[48:51], v[68:71], a[8:11], v[48:51]
  v_mfma_f32_16x16x32_f16 v[52:55], v[68:71], a[40:43], v[52:55]
  v_mfma_f32_16x16x32_f16 v[56:59], v[68:71], a[72:75], v[56:59]
  ds_read_b64 v[84:85], v24 offset:2624
  ds_read_b64 v[86:87], v24 offset:2632
  v_mfma_f32_16x16x32_f16 v[60:63], v[68:71], a[104:107], v[60:63]
  v_mfma_f32_16x16x32_f16 v[48:51], v[72:75], a[4:7], v[48:51]
  v_mfma_f32_16x16x32_f16 v[52:55], v[72:75], a[36:39], v[52:55]
  ds_read_b64 v[88:89], v24 offset:2688
  ds_read_b64 v[90:91], v24 offset:2696
  v_mfma_f32_16x16x32_f16 v[56:59], v[72:75], a[68:71], v[56:59]
  v_mfma_f32_16x16x32_f16 v[60:63], v[72:75], a[100:103], v[60:63]
  s_waitcnt lgkmcnt(4)
  v_mfma_f32_16x16x32_f16 v[48:51], v[76:79], a[0:3], v[48:51]
  ds_read_b64 v[92:93], v24 offset:2752
  ds_read_b64 v[94:95], v24 offset:2760
  v_mfma_f32_16x16x32_f16 v[52:55], v[76:79], a[32:35], v[52:55]
  ds_read_b64 v[126:127], v27 offset:2048
  v_mfma_f32_16x16x32_f16 v[56:59], v[76:79], a[64:67], v[56:59]
  v_mfma_f32_16x16x32_f16 v[60:63], v[76:79], a[96:99], v[60:63]
  ds_read_b64 v[96:97], v24 offset:2816
  ds_read_b64 v[98:99], v24 offset:2824
  v_mfma_f32_16x16x32_f16 v[52:55], v[80:83], a[28:31], v[52:55]
  v_mfma_f32_16x16x32_f16 v[56:59], v[80:83], a[60:63], v[56:59]
  v_mfma_f32_16x16x32_f16 v[60:63], v[80:83], a[92:95], v[60:63]
  ds_read_b64 v[100:101], v24 offset:2880
  ds_read_b64 v[102:103], v24 offset:2888
  s_waitcnt lgkmcnt(5)
  v_mfma_f32_16x16x32_f16 v[52:55], v[84:87], a[24:27], v[52:55]
  v_cvt_pk_bf16_f32 v112, 0, v48
  v_cvt_pk_bf16_f32 v113, 0, v49
  v_mfma_f32_16x16x32_f16 v[56:59], v[84:87], a[56:59], v[56:59]
  v_cvt_pk_bf16_f32 v114, 0, v50
  v_cvt_pk_bf16_f32 v115, 0, v51
  v_mfma_f32_16x16x32_f16 v[60:63], v[84:87], a[88:91], v[60:63]
  ds_read_b64 v[104:105], v24 offset:2944
  ds_read_b64 v[106:107], v24 offset:2952
  v_mfma_f32_16x16x32_f16 v[52:55], v[88:91], a[20:23], v[52:55]
  s_waitcnt lgkmcnt(4)
  v_fma_mix_f32 v116, v126, s79, 0 op_sel_hi:[1,0,0]
  v_mfma_f32_16x16x32_f16 v[56:59], v[88:91], a[52:55], v[56:59]
  v_fma_mix_f32 v117, v126, s79, 0 op_sel:[1,0,0] op_sel_hi:[1,0,0]
  v_fma_mix_f32 v118, v127, s79, 0 op_sel_hi:[1,0,0]
  v_mfma_f32_16x16x32_f16 v[60:63], v[88:91], a[84:87], v[60:63]
  ds_read_b64 v[108:109], v24 offset:3008
  ds_read_b64 v[110:111], v24 offset:3016
  v_mfma_f32_16x16x32_f16 v[52:55], v[92:95], a[16:19], v[52:55]
  v_fma_mix_f32 v119, v127, s79, 0 op_sel:[1,0,0] op_sel_hi:[1,0,0]
  v_cvt_pk_bf16_f32 v116, 0, v116
  v_mfma_f32_16x16x32_f16 v[56:59], v[92:95], a[48:51], v[56:59]
  v_cvt_pk_bf16_f32 v117, 0, v117
  v_cvt_pk_bf16_f32 v118, 0, v118
  v_mfma_f32_16x16x32_f16 v[60:63], v[92:95], a[80:83], v[60:63]
  ds_read_b64 v[64:65], v24 offset:3072
  ds_read_b64 v[66:67], v24 offset:3080
  v_mfma_f32_16x16x32_f16 v[52:55], v[96:99], a[12:15], v[52:55]
  v_cvt_pk_bf16_f32 v119, 0, v119
  v_fmac_f32 v116, v30, v112
  v_mfma_f32_16x16x32_f16 v[56:59], v[96:99], a[44:47], v[56:59]
  ds_read_b64 v[68:69], v24 offset:3136
  ds_read_b64 v[70:71], v24 offset:3144
  v_mfma_f32_16x16x32_f16 v[60:63], v[96:99], a[76:79], v[60:63]
  v_fmac_f32 v117, v30, v113
  s_waitcnt lgkmcnt(4)
  v_mfma_f32_16x16x32_f16 v[52:55], v[100:103], a[8:11], v[52:55]
  ds_read_b64 v[72:73], v24 offset:3200
  ds_read_b64 v[74:75], v24 offset:3208
  v_mfma_f32_16x16x32_f16 v[56:59], v[100:103], a[40:43], v[56:59]
  v_fmac_f32 v118, v30, v114
  v_fmac_f32 v119, v30, v115
  v_mfma_f32_16x16x32_f16 v[60:63], v[100:103], a[72:75], v[60:63]
  ds_read_b64 v[76:77], v24 offset:3264
  ds_read_b64 v[78:79], v24 offset:3272
  v_mfma_f32_16x16x32_f16 v[52:55], v[104:107], a[4:7], v[52:55]
  v_cvt_pk_bf16_f32 v112, v116, v117
  v_cvt_pk_bf16_f32 v113, v118, v119
  v_mfma_f32_16x16x32_f16 v[56:59], v[104:107], a[36:39], v[56:59]
  ds_read_b64 v[80:81], v24 offset:3328
  ds_read_b64 v[82:83], v24 offset:3336
  v_mfma_f32_16x16x32_f16 v[60:63], v[104:107], a[68:71], v[60:63]
  v_mfma_f32_16x16x32_f16 v[52:55], v[108:111], a[0:3], v[52:55]
  ds_read_b64 v[84:85], v24 offset:3392
  ds_read_b64 v[86:87], v24 offset:3400
  v_mfma_f32_16x16x32_f16 v[56:59], v[108:111], a[32:35], v[56:59]
  v_permlane16_swap_b32 v112, v114
  v_permlane16_swap_b32 v113, v115
  v_mfma_f32_16x16x32_f16 v[60:63], v[108:111], a[64:67], v[60:63]
  ds_read_b64 v[88:89], v24 offset:3456
  ds_read_b64 v[90:91], v24 offset:3464
  s_waitcnt lgkmcnt(6)
  v_mfma_f32_16x16x32_f16 v[56:59], v[64:67], a[28:31], v[56:59]
  buffer_store_dwordx4 v[112:115], v26, s[8:11], s77 offen offset:2048 sc1
  ds_read_b64 v[142:143], v27 offset:2560
  v_mfma_f32_16x16x32_f16 v[60:63], v[64:67], a[60:63], v[60:63]
  ds_read_b64 v[92:93], v24 offset:3520
  ds_read_b64 v[94:95], v24 offset:3528
  v_mfma_f32_16x16x32_f16 v[56:59], v[68:71], a[24:27], v[56:59]
  v_mfma_f32_16x16x32_f16 v[60:63], v[68:71], a[56:59], v[60:63]
  ds_read_b64 v[96:97], v24 offset:3584
  ds_read_b64 v[98:99], v24 offset:3592
  v_mfma_f32_16x16x32_f16 v[56:59], v[72:75], a[20:23], v[56:59]
  ds_read_b64 v[100:101], v24 offset:3648
  ds_read_b64 v[102:103], v24 offset:3656
  v_mfma_f32_16x16x32_f16 v[60:63], v[72:75], a[52:55], v[60:63]
  v_cvt_pk_bf16_f32 v128, 0, v52
  v_cvt_pk_bf16_f32 v129, 0, v53
  v_mfma_f32_16x16x32_f16 v[56:59], v[76:79], a[16:19], v[56:59]
  v_cvt_pk_bf16_f32 v130, 0, v54
  v_cvt_pk_bf16_f32 v131, 0, v55
  v_mfma_f32_16x16x32_f16 v[60:63], v[76:79], a[48:51], v[60:63]
  s_waitcnt lgkmcnt(4)
  v_mfma_f32_16x16x32_f16 v[56:59], v[80:83], a[12:15], v[56:59]
  ds_read_b64 v[104:105], v24 offset:3712
  ds_read_b64 v[106:107], v24 offset:3720
  v_mfma_f32_16x16x32_f16 v[60:63], v[80:83], a[44:47], v[60:63]
  ds_read_b64 v[108:109], v24 offset:3776
  ds_read_b64 v[110:111], v24 offset:3784
  v_mfma_f32_16x16x32_f16 v[56:59], v[84:87], a[8:11], v[56:59]
  ds_read_b64 v[64:65], v24 offset:3840
  ds_read_b64 v[66:67], v24 offset:3848
  v_mfma_f32_16x16x32_f16 v[60:63], v[84:87], a[40:43], v[60:63]
  ds_read_b64 v[68:69], v24 offset:3904
  ds_read_b64 v[70:71], v24 offset:3912
  v_mfma_f32_16x16x32_f16 v[56:59], v[88:91], a[4:7], v[56:59]
  ds_read_b64 v[72:73], v24 offset:3968
  ds_read_b64 v[74:75], v24 offset:3976
  v_mfma_f32_16x16x32_f16 v[60:63], v[88:91], a[36:39], v[60:63]
  v_fma_mix_f32 v132, v142, s79, 0 op_sel_hi:[1,0,0]
  v_fma_mix_f32 v133, v142, s79, 0 op_sel:[1,0,0] op_sel_hi:[1,0,0]
  v_mfma_f32_16x16x32_f16 v[56:59], v[92:95], a[0:3], v[56:59]
  v_fma_mix_f32 v134, v143, s79, 0 op_sel_hi:[1,0,0]
  v_fma_mix_f32 v135, v143, s79, 0 op_sel:[1,0,0] op_sel_hi:[1,0,0]
  v_mfma_f32_16x16x32_f16 v[60:63], v[92:95], a[32:35], v[60:63]
  v_cvt_pk_bf16_f32 v132, 0, v132
  s_waitcnt lgkmcnt(6)
  v_mfma_f32_16x16x32_f16 v[60:63], v[96:99], a[28:31], v[60:63]
  ds_read_b64 v[76:77], v24 offset:4032
  ds_read_b64 v[78:79], v24 offset:4040
  v_mfma_f32_16x16x32_f16 v[60:63], v[100:103], a[24:27], v[60:63]
  v_cvt_pk_bf16_f32 v133, 0, v133
  v_cvt_pk_bf16_f32 v134, 0, v134
  v_mfma_f32_16x16x32_f16 v[60:63], v[104:107], a[20:23], v[60:63]
  v_cvt_pk_bf16_f32 v135, 0, v135
  v_fmac_f32 v132, v30, v128
  v_mfma_f32_16x16x32_f16 v[60:63], v[108:111], a[16:19], v[60:63]
  v_fmac_f32 v133, v30, v129
  s_waitcnt lgkmcnt(2)
  v_mfma_f32_16x16x32_f16 v[60:63], v[64:67], a[12:15], v[60:63]
  v_fmac_f32 v134, v30, v130
  v_fmac_f32 v135, v30, v131
  v_mfma_f32_16x16x32_f16 v[60:63], v[68:71], a[8:11], v[60:63]
  v_cvt_pk_bf16_f32 v128, v132, v133
  v_cvt_pk_bf16_f32 v129, v134, v135
  v_mfma_f32_16x16x32_f16 v[60:63], v[72:75], a[4:7], v[60:63]
  s_waitcnt lgkmcnt(0)
  v_mfma_f32_16x16x32_f16 v[60:63], v[76:79], a[0:3], v[60:63]
  s_nop 7
  v_permlane16_swap_b32 v128, v130
  v_permlane16_swap_b32 v129, v131
  buffer_store_dwordx4 v[128:131], v26, s[8:11], s77 offen offset:2560 sc1
  ds_read_b64 v[126:127], v27 offset:3072
  v_cvt_pk_bf16_f32 v112, 0, v56
  v_cvt_pk_bf16_f32 v113, 0, v57
  v_cvt_pk_bf16_f32 v114, 0, v58
  v_cvt_pk_bf16_f32 v115, 0, v59
  s_waitcnt lgkmcnt(0)
  v_fma_mix_f32 v116, v126, s79, 0 op_sel_hi:[1,0,0]
  v_fma_mix_f32 v117, v126, s79, 0 op_sel:[1,0,0] op_sel_hi:[1,0,0]
  v_fma_mix_f32 v118, v127, s79, 0 op_sel_hi:[1,0,0]
  v_fma_mix_f32 v119, v127, s79, 0 op_sel:[1,0,0] op_sel_hi:[1,0,0]
  v_cvt_pk_bf16_f32 v116, 0, v116
  v_cvt_pk_bf16_f32 v117, 0, v117
  v_cvt_pk_bf16_f32 v118, 0, v118
  v_cvt_pk_bf16_f32 v119, 0, v119
  v_fmac_f32 v116, v30, v112
  v_fmac_f32 v117, v30, v113
  v_fmac_f32 v118, v30, v114
  v_fmac_f32 v119, v30, v115
  v_cvt_pk_bf16_f32 v112, v116, v117
  v_cvt_pk_bf16_f32 v113, v118, v119
  s_nop 1
  v_permlane16_swap_b32 v112, v114
  v_permlane16_swap_b32 v113, v115
  buffer_store_dwordx4 v[112:115], v26, s[8:11], s77 offen offset:3072 sc1
  ds_read_b64 v[142:143], v27 offset:3584
  v_cvt_pk_bf16_f32 v128, 0, v60
  v_cvt_pk_bf16_f32 v129, 0, v61
  v_cvt_pk_bf16_f32 v130, 0, v62
  v_cvt_pk_bf16_f32 v131, 0, v63
  s_waitcnt lgkmcnt(0)
  v_fma_mix_f32 v132, v142, s79, 0 op_sel_hi:[1,0,0]
  v_fma_mix_f32 v133, v142, s79, 0 op_sel:[1,0,0] op_sel_hi:[1,0,0]
  v_fma_mix_f32 v134, v143, s79, 0 op_sel_hi:[1,0,0]
  v_fma_mix_f32 v135, v143, s79, 0 op_sel:[1,0,0] op_sel_hi:[1,0,0]
  v_cvt_pk_bf16_f32 v132, 0, v132
  v_cvt_pk_bf16_f32 v133, 0, v133
  v_cvt_pk_bf16_f32 v134, 0, v134
  v_cvt_pk_bf16_f32 v135, 0, v135
  v_fmac_f32 v132, v30, v128
  v_fmac_f32 v133, v30, v129
  v_fmac_f32 v134, v30, v130
  v_fmac_f32 v135, v30, v131
  v_cvt_pk_bf16_f32 v128, v132, v133
  v_cvt_pk_bf16_f32 v129, v134, v135
  s_nop 1
  v_permlane16_swap_b32 v128, v130
  v_permlane16_swap_b32 v129, v131
  buffer_store_dwordx4 v[128:131], v26, s[8:11], s77 offen offset:3584 sc1
  s_cmp_lt_u32 s3, 2
  s_cbranch_scc1 m3_4
  s_mov_b64 s[58:59], 0
m3_4:
  s_mov_b32 s46, 0
apollc_5:
  s_mov_b64 exec, s[54:55]
  s_cbranch_execz apollc_5_sk0
  buffer_load_dwordx4 v[8:11], v3, s[8:11], s43 offen sc1
apollc_5_sk0:
  s_mov_b64 exec, s[56:57]
  s_cbranch_execz apollc_5_sk1
  buffer_load_dwordx4 v[12:15], v3, s[8:11], s44 offen sc1
apollc_5_sk1:
  s_mov_b64 exec, s[58:59]
  s_cbranch_execz apollc_5_sk2
  buffer_load_dwordx4 v[16:19], v3, s[8:11], s45 offen sc1
apollc_5_sk2:
  s_mov_b64 exec, -1
  s_waitcnt vmcnt(0)
apollc_5_chk:
  v_max3_u32 v20, v8, v9, v10
  v_max_u32 v20, v20, v11
  v_cmp_eq_u32 vcc, -1, v20
  s_and_b64 s[54:55], s[54:55], vcc
  v_max3_u32 v20, v12, v13, v14
  v_max_u32 v20, v20, v15
  v_cmp_eq_u32 vcc, -1, v20
  s_and_b64 s[56:57], s[56:57], vcc
  v_max3_u32 v20, v16, v17, v18
  v_max_u32 v20, v20, v19
  v_cmp_eq_u32 vcc, -1, v20
  s_and_b64 s[58:59], s[58:59], vcc
  s_or_b64 vcc, s[54:55], s[56:57]
  s_or_b64 vcc, vcc, s[58:59]
  s_cmp_eq_u64 vcc, 0
  s_cbranch_scc1 apollc_5_done
  s_add_u32 s46, s46, 1
  s_sleep 2
  s_cmp_lt_u32 s46, 40000
  s_cbranch_scc1 apollc_5
apollc_5_done:
  s_branch k_ln2c
k_ffn_pre:
  s_mov_b32 s24, s62
  s_mov_b32 s25, s63
  s_mov_b32 s26, 0x1e0000
  s_mov_b32 s27, 0x20000
  s_mov_b32 s28, s64
  s_mov_b32 s29, s65
  s_mov_b32 s30, 0x1e0000
  s_mov_b32 s31, 0x20000
  s_mov_b32 s32, s66
  s_mov_b32 s33, s67
  s_mov_b32 s34, 0x1e0000
  s_mov_b32 s35, 0x20000
  s_and_b32 s39, s38, 7
  s_lshr_b32 s42, s38, 3
  s_mul_i32 s52, s42, 160
  v_add_u32 v8, s52, v0
  v_mul_u32_u24 v9, 0x5556, v8
  v_lshrrev_b32 v9, 16, v9
  v_mul_u32_u24 v10, 3, v9
  v_sub_u32 v10, v8, v10
  v_mul_u32_u24 v9, 3072, v9
  v_lshl_add_u32 v9, v10, 7, v9
  s_mul_i32 s52, s39, 384
  v_mov_b32 v11, 0x7fffffff
  v_cmp_gt_u32 vcc, 160, v0
  s_lshl_b32 s53, s42, 8
  v_add_u32 v12, s53, v0
  v_cndmask_b32 v9, v11, v9, vcc
  buffer_load_dword v160, v9, s[24:27], s52 offen
  buffer_load_dword v161, v9, s[28:31], s52 offen
  v_lshrrev_b32 v10, 1, v12
  v_mul_u32_u24 v10, 1280, v10
  v_and_b32 v12, 1, v12
  v_lshl_add_u32 v10, v12, 7, v10
  s_mul_i32 s52, s39, 160
  s_and_b32 s52, s52, 0xffffff80
  buffer_load_dword v162, v10, s[32:35], s52 offen
  s_sub_u32 s38, s2, 160
  s_and_b32 s39, s38, 7
  s_lshr_b32 s42, s38, 3
  s_mul_i32 s36, s39, 12
  s_add_u32 s36, s36, s42
  s_mul_i32 s37, s39, 10
  s_add_u32 s37, s37, s42
  v_lshrrev_b32 v3, 1, v0
  s_movk_i32 s46, 3072
  v_mul_lo_u32 v3, v3, s46
  v_and_b32 v4, 1, v0
  v_lshl_add_u32 v3, v4, 4, v3
  s_lshl_b32 s43, s36, 5
  s_lshl_b32 s44, s3, 10
  s_add_u32 s45, s43, 0
  s_add_u32 s47, s44, 19712
  s_mov_b32 m0, s47
  s_nop 0
  buffer_load_dwordx4 v3, s[24:27], s45 offen lds
  s_add_u32 s47, s44, 40192
  s_mov_b32 m0, s47
  s_nop 0
  buffer_load_dwordx4 v3, s[28:31], s45 offen lds
  s_add_u32 s45, s43, 393216
  s_add_u32 s47, s44, 23808
  s_mov_b32 m0, s47
  s_nop 0
  buffer_load_dwordx4 v3, s[24:27], s45 offen lds
  s_add_u32 s47, s44, 44288
  s_mov_b32 m0, s47
  s_nop 0
  buffer_load_dwordx4 v3, s[28:31], s45 offen lds
  s_add_u32 s45, s43, 786432
  s_add_u32 s47, s44, 27904
  s_mov_b32 m0, s47
  s_nop 0
  buffer_load_dwordx4 v3, s[24:27], s45 offen lds
  s_add_u32 s47, s44, 48384
  s_mov_b32 m0, s47
  s_nop 0
  buffer_load_dwordx4 v3, s[28:31], s45 offen lds
  s_add_u32 s45, s43, 1179648
  s_add_u32 s47, s44, 32000
  s_mov_b32 m0, s47
  s_nop 0
  buffer_load_dwordx4 v3, s[24:27], s45 offen lds
  s_add_u32 s47, s44, 52480
  s_mov_b32 m0, s47
  s_nop 0
  buffer_load_dwordx4 v3, s[28:31], s45 offen lds
  s_add_u32 s45, s43, 1572864
  s_add_u32 s47, s44, 36096
  s_mov_b32 m0, s47
  s_nop 0
  buffer_load_dwordx4 v3, s[24:27], s45 offen lds
  s_add_u32 s47, s44, 56576
  s_mov_b32 m0, s47
  s_nop 0
  buffer_load_dwordx4 v3, s[28:31], s45 offen lds
  s_cmp_ge_u32 s38, 80
  s_cbranch_scc1 k_ffn_nowd
  s_movk_i32 s46, 1280
  v_mul_lo_u32 v3, v0, s46
  s_lshl_b32 s43, s37, 4
  s_add_u32 s45, s43, 0
  s_add_u32 s47, s44, 60672
  s_mov_b32 m0, s47
  s_nop 0
  buffer_load_dwordx4 v3, s[32:35], s45 offen lds
  s_add_u32 s45, s43, 327680
  s_add_u32 s47, s44, 64768
  s_mov_b32 m0, s47
  s_nop 0
  buffer_load_dwordx4 v3, s[32:35], s45 offen lds
  s_add_u32 s45, s43, 655360
  s_add_u32 s47, s44, 68864
  s_mov_b32 m0, s47
  s_nop 0
  buffer_load_dwordx4 v3, s[32:35], s45 offen lds
  s_add_u32 s45, s43, 983040
  s_add_u32 s47, s44, 72960
  s_mov_b32 m0, s47
  s_nop 0
  buffer_load_dwordx4 v3, s[32:35], s45 offen lds
  s_add_u32 s45, s43, 1310720
  s_add_u32 s47, s44, 77056
  s_mov_b32 m0, s47
  s_nop 0
  buffer_load_dwordx4 v3, s[32:35], s45 offen lds
  s_add_u32 s45, s43, 1638400
  s_add_u32 s47, s44, 81152
  s_mov_b32 m0, s47
  s_nop 0
  buffer_load_dwordx4 v3, s[32:35], s45 offen lds
k_ffn_nowd:
  v_lshlrev_b32 v196, 4, v1
  s_and_b32 s51, s2, 7
  s_lshl_b32 s51, s51, 10
  s_add_u32 s51, s51, 5439488
  s_mov_b64 s[54:55], -1
  s_mov_b32 s53, 0
flg_6:
  s_mov_b64 exec, s[54:55]
  buffer_load_dwordx4 v[192:195], v196, s[8:11], s51 offen sc1
  s_mov_b64 exec, -1
flg_6_chk:
  s_waitcnt vmcnt(0)
  v_xor_b32 v192, s72, v192
  v_xor_b32 v193, s72, v193
  v_xor_b32 v194, s72, v194
  v_xor_b32 v195, s72, v195
  v_or3_b32 v197, v192, v193, v194
  v_or_b32 v197, v197, v195
  v_cmp_ne_u32 vcc, 0, v197
  s_and_b64 s[54:55], s[54:55], vcc
  s_cmp_eq_u64 s[54:55], 0
  s_cbranch_scc1 flg_6_done
  s_add_u32 s53, s53, 1
  s_sleep 8
  s_cmp_lt_u32 s53, 40000
  s_cbranch_scc1 flg_6
flg_6_done:
  s_cmp_lg_u32 s3, 0
  s_cbranch_scc1 k_can_done
  v_lshlrev_b32 v3, 12, v0
  s_and_b32 s43, s40, 31
  s_add_u32 s43, s43, 96
  s_lshl_b32 s43, s43, 4
  s_add_u32 s43, s43, 2621440
  s_mov_b64 s[54:55], -1
  s_mov_b32 s46, 0
can_7:
  s_mov_b64 exec, s[54:55]
  s_cbranch_execz can_7_sk0
  buffer_load_dwordx4 v[8:11], v3, s[8:11], s43 offen sc1
can_7_sk0:
  s_mov_b64 exec, -1
  s_waitcnt vmcnt(0)
can_7_chk:
  v_max3_u32 v12, v8, v9, v10
  v_max_u32 v12, v12, v11
  v_cmp_eq_u32 vcc, -1, v12
  s_and_b64 s[54:55], s[54:55], vcc
  s_cmp_eq_u64 s[54:55], 0
  s_cbranch_scc1 can_7_done
  s_add_u32 s46, s46, 1
  s_sleep 8
  s_cmp_lt_u32 s46, 40000
  s_cbranch_scc1 can_7
can_7_done:
k_can_done:
  s_barrier
  s_branch k_ln2b
k_ln2b:
  v_lshlrev_b32 v3, 12, v0
  s_lshl_b32 s43, s41, 1
  s_add_u32 s43, s43, 2621440
  s_add_u32 s44, s43, 1048576
  s_add_u32 s45, s43, 2097152
  s_mov_b64 s[54:55], -1
  s_mov_b64 s[56:57], -1
  s_mov_b64 s[58:59], -1
  s_cmp_lt_u32 s3, 2
  s_cbranch_scc1 m3_8
  s_mov_b64 s[58:59], 0
m3_8:
  s_mov_b32 s46, 0
apoll_9:
  s_mov_b64 exec, s[54:55]
  s_cbranch_execz apoll_9_sk0
  buffer_load_dwordx4 v[8:11], v3, s[8:11], s43 offen sc1
apoll_9_sk0:
  s_mov_b64 exec, s[56:57]
  s_cbranch_execz apoll_9_sk1
  buffer_load_dwordx4 v[12:15], v3, s[8:11], s44 offen sc1
apoll_9_sk1:
  s_mov_b64 exec, s[58:59]
  s_cbranch_execz apoll_9_sk2
  buffer_load_dwordx4 v[16:19], v3, s[8:11], s45 offen sc1
apoll_9_sk2:
  s_mov_b64 exec, -1
  s_waitcnt vmcnt(0)
apoll_9_chk:
  v_max3_u32 v20, v8, v9, v10
  v_max_u32 v20, v20, v11
  v_cmp_eq_u32 vcc, -1, v20
  s_and_b64 s[54:55], s[54:55], vcc
  v_max3_u32 v20, v12, v13, v14
  v_max_u32 v20, v20, v15
  v_cmp_eq_u32 vcc, -1, v20
  s_and_b64 s[56:57], s[56:57], vcc
  v_max3_u32 v20, v16, v17, v18
  v_max_u32 v20, v20, v19
  v_cmp_eq_u32 vcc, -1, v20
  s_and_b64 s[58:59], s[58:59], vcc
  s_or_b64 vcc, s[54:55], s[56:57]
  s_or_b64 vcc, vcc, s[58:59]
  s_cmp_eq_u64 vcc, 0
  s_cbranch_scc1 apoll_9_done
  s_add_u32 s46, s46, 1
  s_sleep 2
  s_cmp_lt_u32 s46, 40000
  s_cbranch_scc1 apoll_9
apoll_9_done:
k_ln2c:
  v_lshlrev_b32 v3, 4, v0
  ds_write_b128 v3, v[8:11] offset:0
  ds_write_b128 v3, v[12:15] offset:4096
  s_cmp_ge_u32 s3, 2
  s_cbranch_scc1 k_ln2_w3
  ds_write_b128 v3, v[16:19] offset:8192
k_ln2_w3:
  v_lshrrev_b32 v8, 4, v1
  v_lshlrev_b32 v8, 3, v8
  v_bfe_u32 v9, v1, 1, 1
  v_lshl_add_u32 v8, v9, 2, v8
  v_bfe_u32 v9, v1, 2, 2
  v_add_u32 v8, v8, v9
  s_mul_i32 s47, s3, 160
  v_add_u32 v8, s47, v8
  v_lshlrev_b32 v8, 4, v8
  v_and_b32 v9, 1, v1
  v_lshl_add_u32 v8, v9, 3, v8
  s_waitcnt lgkmcnt(0)
  s_barrier
  ds_read_b64_tr_b16 v[30:31], v8 offset:0
  ds_read_b64_tr_b16 v[32:33], v8 offset:512
  ds_read_b64_tr_b16 v[34:35], v8 offset:1024
  ds_read_b64_tr_b16 v[36:37], v8 offset:1536
  ds_read_b64_tr_b16 v[38:39], v8 offset:2048
  s_waitcnt lgkmcnt(4)
  v_lshlrev_b32 v40, 16, v30
  v_and_b32 v41, 0xffff0000, v30
  v_pk_add_f32 v[40:41], v[40:41], v[220:221]
  v_cvt_pk_bf16_f32 v40, 0, v40
  v_cvt_pk_bf16_f32 v41, 0, v41
  v_lshlrev_b32 v42, 16, v31
  v_and_b32 v43, 0xffff0000, v31
  v_pk_add_f32 v[42:43], v[42:43], v[222:223]
  v_cvt_pk_bf16_f32 v42, 0, v42
  v_cvt_pk_bf16_f32 v43, 0, v43
  s_waitcnt lgkmcnt(3)
  v_lshlrev_b32 v44, 16, v32
  v_and_b32 v45, 0xffff0000, v32
  v_pk_add_f32 v[44:45], v[44:45], v[224:225]
  v_cvt_pk_bf16_f32 v44, 0, v44
  v_cvt_pk_bf16_f32 v45, 0, v45
  v_lshlrev_b32 v46, 16, v33
  v_and_b32 v47, 0xffff0000, v33
  v_pk_add_f32 v[46:47], v[46:47], v[226:227]
  v_cvt_pk_bf16_f32 v46, 0, v46
  v_cvt_pk_bf16_f32 v47, 0, v47
  s_waitcnt lgkmcnt(2)
  v_lshlrev_b32 v48, 16, v34
  v_and_b32 v49, 0xffff0000, v34
  v_pk_add_f32 v[48:49], v[48:49], v[228:229]
  v_cvt_pk_bf16_f32 v48, 0, v48
  v_cvt_pk_bf16_f32 v49, 0, v49
  v_lshlrev_b32 v50, 16, v35
  v_and_b32 v51, 0xffff0000, v35
  v_pk_add_f32 v[50:51], v[50:51], v[230:231]
  v_cvt_pk_bf16_f32 v50, 0, v50
  v_cvt_pk_bf16_f32 v51, 0, v51
  s_waitcnt lgkmcnt(1)
  v_lshlrev_b32 v52, 16, v36
  v_and_b32 v53, 0xffff0000, v36
  v_pk_add_f32 v[52:53], v[52:53], v[232:233]
  v_cvt_pk_bf16_f32 v52, 0, v52
  v_cvt_pk_bf16_f32 v53, 0, v53
  v_lshlrev_b32 v54, 16, v37
  v_and_b32 v55, 0xffff0000, v37
  v_pk_add_f32 v[54:55], v[54:55], v[234:235]
  v_cvt_pk_bf16_f32 v54, 0, v54
  v_cvt_pk_bf16_f32 v55, 0, v55
  s_waitcnt lgkmcnt(0)
  v_lshlrev_b32 v56, 16, v38
  v_and_b32 v57, 0xffff0000, v38
  v_pk_add_f32 v[56:57], v[56:57], v[236:237]
  v_cvt_pk_bf16_f32 v56, 0, v56
  v_cvt_pk_bf16_f32 v57, 0, v57
  v_lshlrev_b32 v58, 16, v39
  v_and_b32 v59, 0xffff0000, v39
  v_pk_add_f32 v[58:59], v[58:59], v[238:239]
  v_cvt_pk_bf16_f32 v58, 0, v58
  v_cvt_pk_bf16_f32 v59, 0, v59
  v_pk_add_f32 v[72:73], v[40:41], v[42:43]
  v_pk_add_f32 v[74:75], v[44:45], v[46:47]
  v_pk_add_f32 v[72:73], v[72:73], v[48:49]
  v_pk_add_f32 v[74:75], v[74:75], v[50:51]
  v_pk_add_f32 v[72:73], v[72:73], v[52:53]
  v_pk_add_f32 v[74:75], v[74:75], v[54:55]
  v_pk_add_f32 v[72:73], v[72:73], v[56:57]
  v_pk_add_f32 v[74:75], v[74:75], v[58:59]
  v_pk_add_f32 v[72:73], v[72:73], v[74:75]
  v_add_f32 v72, v72, v73
  s_nop 1
  v_add_f32_dpp v72, v72, v72 row_ror:8 row_mask:0xf bank_mask:0xf
  v_mov_b32 v73, v72
  s_nop 1
  v_permlane16_swap_b32 v72, v73
  s_nop 1
  v_add_f32 v72, v72, v73
  v_mov_b32 v73, v72
  s_nop 1
  v_permlane32_swap_b32 v72, v73
  s_nop 1
  v_add_f32 v72, v72, v73
  v_mul_f32 v72, 0x3bcccccd, v72
  v_pk_add_f32 v[70:71], v[40:41], v[72:73] op_sel_hi:[1,0] neg_lo:[0,1] neg_hi:[0,1]
  v_pk_mul_f32 v[74:75], v[70:71], v[70:71]
  v_pk_add_f32 v[76:77], v[42:43], v[72:73] op_sel_hi:[1,0] neg_lo:[0,1] neg_hi:[0,1]
  v_pk_mul_f32 v[82:83], v[76:77], v[76:77]
  v_pk_add_f32 v[70:71], v[44:45], v[72:73] op_sel_hi:[1,0] neg_lo:[0,1] neg_hi:[0,1]
  v_pk_fma_f32 v[74:75], v[70:71], v[70:71], v[74:75]
  v_pk_add_f32 v[76:77], v[46:47], v[72:73] op_sel_hi:[1,0] neg_lo:[0,1] neg_hi:[0,1]
  v_pk_fma_f32 v[82:83], v[76:77], v[76:77], v[82:83]
  v_pk_add_f32 v[70:71], v[48:49], v[72:73] op_sel_hi:[1,0] neg_lo:[0,1] neg_hi:[0,1]
  v_pk_fma_f32 v[74:75], v[70:71], v[70:71], v[74:75]
  v_pk_add_f32 v[76:77], v[50:51], v[72:73] op_sel_hi:[1,0] neg_lo:[0,1] neg_hi:[0,1]
  v_pk_fma_f32 v[82:83], v[76:77], v[76:77], v[82:83]
  v_pk_add_f32 v[70:71], v[52:53], v[72:73] op_sel_hi:[1,0] neg_lo:[0,1] neg_hi:[0,1]
  v_pk_fma_f32 v[74:75], v[70:71], v[70:71], v[74:75]
  v_pk_add_f32 v[76:77], v[54:55], v[72:73] op_sel_hi:[1,0] neg_lo:[0,1] neg_hi:[0,1]
  v_pk_fma_f32 v[82:83], v[76:77], v[76:77], v[82:83]
  v_pk_add_f32 v[70:71], v[56:57], v[72:73] op_sel_hi:[1,0] neg_lo:[0,1] neg_hi:[0,1]
  v_pk_fma_f32 v[74:75], v[70:71], v[70:71], v[74:75]
  v_pk_add_f32 v[76:77], v[58:59], v[72:73] op_sel_hi:[1,0] neg_lo:[0,1] neg_hi:[0,1]
  v_pk_fma_f32 v[82:83], v[76:77], v[76:77], v[82:83]
  v_pk_add_f32 v[74:75], v[74:75], v[82:83]
  v_add_f32 v73, v74, v75
  s_nop 1
  v_add_f32_dpp v73, v73, v73 row_ror:8 row_mask:0xf bank_mask:0xf
  v_mov_b32 v74, v73
  s_nop 1
  v_permlane16_swap_b32 v73, v74
  s_nop 1
  v_add_f32 v73, v73, v74
  v_mov_b32 v74, v73
  s_nop 1
  v_permlane32_swap_b32 v73, v74
  s_nop 1
  v_add_f32 v73, v73, v74
  v_lshlrev_b32 v76, 3, v252
  v_add_u32 v76, 10816, v76
  s_lshl_b32 s47, s3, 6
  v_add_u32 v77, s47, v76
  v_cmp_gt_u32 vcc, 8, v1
  s_and_saveexec_b64 s[48:49], vcc
  ds_write_b64 v77, v[72:73]
  s_mov_b64 exec, s[48:49]
  s_waitcnt lgkmcnt(0)
  s_barrier
  ds_read_b64 v[78:79], v76
  ds_read_b64 v[80:81], v76 offset:64
  ds_read_b64 v[82:83], v76 offset:128
  ds_read_b64 v[84:85], v76 offset:192
  s_waitcnt lgkmcnt(0)
  v_add_f32 v72, v78, v80
  v_add_f32 v73, v82, v84
  v_add_f32 v72, v72, v73
  v_mul_f32 v72, 0.25, v72
  v_sub_f32 v78, v78, v72
  v_sub_f32 v80, v80, v72
  v_sub_f32 v82, v82, v72
  v_sub_f32 v84, v84, v72
  v_mul_f32 v73, v78, v78
  v_fmac_f32 v73, v80, v80
  v_fmac_f32 v73, v82, v82
  v_fmac_f32 v73, v84, v84
  v_add_f32 v79, v79, v81
  v_add_f32 v83, v83, v85
  v_add_f32 v79, v79, v83
  v_fmac_f32 v79, 0x43200000, v73
  v_mul_f32 v74, 0x3acccccd, v79
  v_cvt_pk_bf16_f32 v78, 0, v72
  v_cvt_pk_bf16_f32 v75, 0, v74
  v_add_f32 v75, 0x3727c5ac, v75
  v_cvt_pk_bf16_f32 v75, 0, v75
  v_sqrt_f32 v75, v75
  s_nop 0
  v_cvt_pk_bf16_f32 v75, 0, v75
  v_rcp_f32 v80, v75
  s_nop 0
  v_mov_b32 v82, 0
  v_mov_b32 v83, 0
  v_pk_add_f32 v[86:87], v[40:41], v[78:79] op_sel_hi:[1,0] neg_lo:[0,1] neg_hi:[0,1]
  v_cvt_pk_bf16_f32 v86, 0, v86
  v_cvt_pk_bf16_f32 v87, 0, v87
  v_pk_mul_f32 v[86:87], v[86:87], v[80:81] op_sel_hi:[1,0]
  v_cvt_pk_bf16_f32 v30, v86, v87
  v_dot2_f32_bf16 v82, v30, v240, v82
  v_pk_add_f32 v[88:89], v[42:43], v[78:79] op_sel_hi:[1,0] neg_lo:[0,1] neg_hi:[0,1]
  v_cvt_pk_bf16_f32 v88, 0, v88
  v_cvt_pk_bf16_f32 v89, 0, v89
  v_pk_mul_f32 v[88:89], v[88:89], v[80:81] op_sel_hi:[1,0]
  v_cvt_pk_bf16_f32 v31, v88, v89
  v_dot2_f32_bf16 v83, v31, v241, v83
  v_pk_add_f32 v[86:87], v[44:45], v[78:79] op_sel_hi:[1,0] neg_lo:[0,1] neg_hi:[0,1]
  v_cvt_pk_bf16_f32 v86, 0, v86
  v_cvt_pk_bf16_f32 v87, 0, v87
  v_pk_mul_f32 v[86:87], v[86:87], v[80:81] op_sel_hi:[1,0]
  v_cvt_pk_bf16_f32 v32, v86, v87
  v_dot2_f32_bf16 v82, v32, v242, v82
  v_pk_add_f32 v[88:89], v[46:47], v[78:79] op_sel_hi:[1,0] neg_lo:[0,1] neg_hi:[0,1]
  v_cvt_pk_bf16_f32 v88, 0, v88
  v_cvt_pk_bf16_f32 v89, 0, v89
  v_pk_mul_f32 v[88:89], v[88:89], v[80:81] op_sel_hi:[1,0]
  v_cvt_pk_bf16_f32 v33, v88, v89
  v_dot2_f32_bf16 v83, v33, v243, v83
  v_pk_add_f32 v[86:87], v[48:49], v[78:79] op_sel_hi:[1,0] neg_lo:[0,1] neg_hi:[0,1]
  v_cvt_pk_bf16_f32 v86, 0, v86
  v_cvt_pk_bf16_f32 v87, 0, v87
  v_pk_mul_f32 v[86:87], v[86:87], v[80:81] op_sel_hi:[1,0]
  v_cvt_pk_bf16_f32 v34, v86, v87
  v_dot2_f32_bf16 v82, v34, v244, v82
  v_pk_add_f32 v[88:89], v[50:51], v[78:79] op_sel_hi:[1,0] neg_lo:[0,1] neg_hi:[0,1]
  v_cvt_pk_bf16_f32 v88, 0, v88
  v_cvt_pk_bf16_f32 v89, 0, v89
  v_pk_mul_f32 v[88:89], v[88:89], v[80:81] op_sel_hi:[1,0]
  v_cvt_pk_bf16_f32 v35, v88, v89
  v_dot2_f32_bf16 v83, v35, v245, v83
  v_pk_add_f32 v[86:87], v[52:53], v[78:79] op_sel_hi:[1,0] neg_lo:[0,1] neg_hi:[0,1]
  v_cvt_pk_bf16_f32 v86, 0, v86
  v_cvt_pk_bf16_f32 v87, 0, v87
  v_pk_mul_f32 v[86:87], v[86:87], v[80:81] op_sel_hi:[1,0]
  v_cvt_pk_bf16_f32 v36, v86, v87
  v_dot2_f32_bf16 v82, v36, v246, v82
  v_pk_add_f32 v[88:89], v[54:55], v[78:79] op_sel_hi:[1,0] neg_lo:[0,1] neg_hi:[0,1]
  v_cvt_pk_bf16_f32 v88, 0, v88
  v_cvt_pk_bf16_f32 v89, 0, v89
  v_pk_mul_f32 v[88:89], v[88:89], v[80:81] op_sel_hi:[1,0]
  v_cvt_pk_bf16_f32 v37, v88, v89
  v_dot2_f32_bf16 v83, v37, v247, v83
  v_pk_add_f32 v[86:87], v[56:57], v[78:79] op_sel_hi:[1,0] neg_lo:[0,1] neg_hi:[0,1]
  v_cvt_pk_bf16_f32 v86, 0, v86
  v_cvt_pk_bf16_f32 v87, 0, v87
  v_pk_mul_f32 v[86:87], v[86:87], v[80:81] op_sel_hi:[1,0]
  v_cvt_pk_bf16_f32 v38, v86, v87
  v_dot2_f32_bf16 v82, v38, v248, v82
  v_pk_add_f32 v[88:89], v[58:59], v[78:79] op_sel_hi:[1,0] neg_lo:[0,1] neg_hi:[0,1]
  v_cvt_pk_bf16_f32 v88, 0, v88
  v_cvt_pk_bf16_f32 v89, 0, v89
  v_pk_mul_f32 v[88:89], v[88:89], v[80:81] op_sel_hi:[1,0]
  v_cvt_pk_bf16_f32 v39, v88, v89
  v_dot2_f32_bf16 v83, v39, v249, v83
  s_nop 2
  v_add_f32 v82, v82, v83
  s_nop 1
  v_add_f32_dpp v82, v82, v82 row_ror:8 row_mask:0xf bank_mask:0xf
  v_mov_b32 v83, v82
  s_nop 1
  v_permlane16_swap_b32 v82, v83
  s_nop 1
  v_add_f32 v82, v82, v83
  v_mov_b32 v83, v82
  s_nop 1
  v_permlane32_swap_b32 v82, v83
  s_nop 1
  v_add_f32 v82, v82, v83
  v_lshlrev_b32 v76, 2, v252
  v_add_u32 v76, 11072, v76
  s_lshl_b32 s47, s3, 5
  v_add_u32 v77, s47, v76
  v_cmp_gt_u32 vcc, 8, v1
  s_and_saveexec_b64 s[48:49], vcc
  ds_write_b32 v77, v82
  s_mov_b64 exec, s[48:49]
  s_waitcnt lgkmcnt(0)
  s_barrier
  ds_read_b32 v78, v76
  ds_read_b32 v79, v76 offset:32
  ds_read_b32 v80, v76 offset:64
  ds_read_b32 v81, v76 offset:96
  s_waitcnt lgkmcnt(0)
  v_add_f32 v78, v78, v79
  v_add_f32 v80, v80, v81
  v_add_f32 v78, v78, v80
  v_cvt_pk_bf16_f32 v78, v78, v78
  v_and_b32 v78, 0xffff, v78
  v_xor_b32 v79, 0xffff, v78
  v_or_b32 v80, 0x8000, v78
  v_cmp_lt_u32 vcc, 0x7fff, v78
  v_lshlrev_b32 v87, 16, v78
  s_nop 0
  v_cndmask_b32 v78, v80, v79, vcc
  v_lshlrev_b32 v78, 16, v78
  v_add_u32 v79, s41, v252
  v_sub_u32 v80, 0xffff, v79
  v_or_b32 v86, v78, v80
  s_cmp_lg_u32 s3, 0
  s_cbranch_scc1 k_nokey
  v_lshlrev_b32 v80, 2, v79
  v_lshrrev_b32 v81, 3, v1
  v_lshl_add_u32 v80, v81, 13, v80
  s_mov_b32 s47, 5242880
  buffer_store_dword v86, v80, s[8:11], s47 offen sc1
k_nokey:
  v_lshlrev_b32 v9, 5, v0
  s_and_b32 s47, s2, 7
  s_lshl_b32 s47, s47, 13
  s_add_u32 s47, s47, 5242880
  s_mov_b64 s[54:55], -1
  v_lshlrev_b32 v70, 16, v30
  v_and_b32 v71, 0xffff0000, v30
  v_pk_add_f32 v[70:71], v[70:71], v[40:41]
  v_cvt_pk_bf16_f32 v10, v70, v71
  v_lshlrev_b32 v70, 16, v31
  v_and_b32 v71, 0xffff0000, v31
  v_pk_add_f32 v[70:71], v[70:71], v[42:43]
  v_cvt_pk_bf16_f32 v11, v70, v71
  v_lshlrev_b32 v70, 16, v32
  v_and_b32 v71, 0xffff0000, v32
  v_pk_add_f32 v[70:71], v[70:71], v[44:45]
  v_cvt_pk_bf16_f32 v12, v70, v71
  v_lshlrev_b32 v70, 16, v33
  v_and_b32 v71, 0xffff0000, v33
  v_pk_add_f32 v[70:71], v[70:71], v[46:47]
  v_cvt_pk_bf16_f32 v13, v70, v71
  v_lshlrev_b32 v70, 16, v34
  v_and_b32 v71, 0xffff0000, v34
  v_pk_add_f32 v[70:71], v[70:71], v[48:49]
  v_cvt_pk_bf16_f32 v14, v70, v71
  v_lshlrev_b32 v70, 16, v35
  v_and_b32 v71, 0xffff0000, v35
  v_pk_add_f32 v[70:71], v[70:71], v[50:51]
  v_cvt_pk_bf16_f32 v15, v70, v71
  v_lshlrev_b32 v70, 16, v36
  v_and_b32 v71, 0xffff0000, v36
  v_pk_add_f32 v[70:71], v[70:71], v[52:53]
  v_cvt_pk_bf16_f32 v16, v70, v71
  v_lshlrev_b32 v70, 16, v37
  v_and_b32 v71, 0xffff0000, v37
  v_pk_add_f32 v[70:71], v[70:71], v[54:55]
  v_cvt_pk_bf16_f32 v17, v70, v71
  v_lshlrev_b32 v70, 16, v38
  v_and_b32 v71, 0xffff0000, v38
  v_pk_add_f32 v[70:71], v[70:71], v[56:57]
  v_cvt_pk_bf16_f32 v18, v70, v71
  v_lshlrev_b32 v70, 16, v39
  v_and_b32 v71, 0xffff0000, v39
  v_pk_add_f32 v[70:71], v[70:71], v[58:59]
  v_cvt_pk_bf16_f32 v19, v70, v71
  s_cmp_ge_u32 s2, 160
  s_cbranch_scc1 k_kd
  s_sleep 32
k_kd:
  s_mov_b32 s46, 0
kpoll_10:
  s_mov_b64 exec, s[54:55]
  s_cbranch_execz kpoll_10_sk0
  buffer_load_dwordx4 v[90:93], v9, s[8:11], s47 offen sc1
  buffer_load_dwordx4 v[94:97], v9, s[8:11], s47 offen offset:16 sc1
kpoll_10_sk0:
  s_mov_b64 exec, -1
  s_waitcnt vmcnt(0)
kpoll_10_chk:
  v_min3_u32 v98, v90, v91, v92
  v_min3_u32 v98, v98, v93, v94
  v_min3_u32 v98, v98, v95, v96
  v_min_u32 v98, v98, v97
  v_cmp_eq_u32 vcc, 0, v98
  s_and_b64 s[54:55], s[54:55], vcc
  s_cmp_eq_u64 s[54:55], 0
  s_cbranch_scc1 kpoll_10_done
  s_add_u32 s46, s46, 1
  s_sleep 3
  s_cmp_lt_u32 s46, 40000
  s_cbranch_scc1 kpoll_10
kpoll_10_done:
  s_mov_b32 s50, -1
  s_mov_b64 s[52:53], 0
  s_mov_b32 s51, 0
k_own:
  v_cmp_gt_u32 vcc, s50, v86
  s_nop 1
  v_cndmask_b32 v98, 0, v86, vcc
  s_nop 1
  v_max_u32_dpp v98, v98, v98 quad_perm:[1,0,3,2] row_mask:0xf bank_mask:0xf
  s_nop 1
  v_max_u32_dpp v98, v98, v98 quad_perm:[2,3,0,1] row_mask:0xf bank_mask:0xf
  s_nop 1
  v_max_u32_dpp v98, v98, v98 row_half_mirror row_mask:0xf bank_mask:0xf
  s_nop 0
  v_readfirstlane_b32 s54, v98
  s_nop 3
  s_cmp_eq_u32 s54, 0
  s_cbranch_scc1 k_own_done
  s_mov_b32 s55, 0
  v_cmp_lt_u32 vcc, s54, v90
  s_bcnt1_i32_b64 s56, vcc
  s_add_u32 s55, s55, s56
  v_cmp_lt_u32 vcc, s54, v91
  s_bcnt1_i32_b64 s56, vcc
  s_add_u32 s55, s55, s56
  v_cmp_lt_u32 vcc, s54, v92
  s_bcnt1_i32_b64 s56, vcc
  s_add_u32 s55, s55, s56
  v_cmp_lt_u32 vcc, s54, v93
  s_bcnt1_i32_b64 s56, vcc
  s_add_u32 s55, s55, s56
  v_cmp_lt_u32 vcc, s54, v94
  s_bcnt1_i32_b64 s56, vcc
  s_add_u32 s55, s55, s56
  v_cmp_lt_u32 vcc, s54, v95
  s_bcnt1_i32_b64 s56, vcc
  s_add_u32 s55, s55, s56
  v_cmp_lt_u32 vcc, s54, v96
  s_bcnt1_i32_b64 s56, vcc
  s_add_u32 s55, s55, s56
  v_cmp_lt_u32 vcc, s54, v97
  s_bcnt1_i32_b64 s56, vcc
  s_add_u32 s55, s55, s56
  s_lshl_b32 s56, s51, 4
  s_lshl_b32 s57, s3, 2
  s_add_u32 s57, s57, s56
  s_add_u32 s57, s57, 11200
  v_mov_b32 v99, s57
  v_mov_b32 v100, s55
  s_add_u32 s56, s56, 11200
  v_mov_b32 v101, s56
  s_mov_b64 exec, 1
  ds_write_b32 v99, v100
  s_mov_b64 exec, -1
  s_waitcnt lgkmcnt(0)
  s_barrier
  ds_read_b128 v[102:105], v101
  s_waitcnt lgkmcnt(0)
  v_add_u32 v102, v102, v103
  v_add3_u32 v102, v102, v104, v105
  s_nop 0
  v_readfirstlane_b32 s55, v102
  s_nop 3
  s_cmp_ge_u32 s55, 8
  s_cbranch_scc1 k_own_done
  v_cmp_eq_u32 vcc, s54, v86
  s_or_b64 s[52:53], s[52:53], vcc
  s_and_saveexec_b64 s[48:49], vcc
  s_mul_i32 s56, s55, 1280
  s_add_u32 s57, s56, 5318656
  s_add_u32 s56, s56, 5308416
  buffer_store_dwordx2 v[30:31], v251, s[8:11], s56 offen offset:0 sc1
  buffer_store_dwordx2 v[32:33], v251, s[8:11], s56 offen offset:64 sc1
  buffer_store_dwordx2 v[34:35], v251, s[8:11], s56 offen offset:128 sc1
  buffer_store_dwordx2 v[36:37], v251, s[8:11], s56 offen offset:192 sc1
  buffer_store_dwordx2 v[38:39], v251, s[8:11], s56 offen offset:256 sc1
  v_cvt_pk_bf16_f32 v106, v40, v41
  v_cvt_pk_bf16_f32 v107, v42, v43
  v_cvt_pk_bf16_f32 v108, v44, v45
  v_cvt_pk_bf16_f32 v109, v46, v47
  v_cvt_pk_bf16_f32 v110, v48, v49
  v_cvt_pk_bf16_f32 v111, v50, v51
  v_cvt_pk_bf16_f32 v112, v52, v53
  v_cvt_pk_bf16_f32 v113, v54, v55
  v_cvt_pk_bf16_f32 v114, v56, v57
  v_cvt_pk_bf16_f32 v115, v58, v59
  buffer_store_dwordx2 v[106:107], v251, s[8:11], s57 offen offset:0 sc1
  buffer_store_dwordx2 v[108:109], v251, s[8:11], s57 offen offset:64 sc1
  buffer_store_dwordx2 v[110:111], v251, s[8:11], s57 offen offset:128 sc1
  buffer_store_dwordx2 v[112:113], v251, s[8:11], s57 offen offset:192 sc1
  buffer_store_dwordx2 v[114:115], v251, s[8:11], s57 offen offset:256 sc1
  s_cmp_lg_u32 s3, 0
  s_cbranch_scc1 k_own_nometa
  v_cmp_gt_u32 vcc, 8, v1
  s_and_b64 exec, exec, vcc
  v_mul_f32 v99, 0x3fb8aa3b, v87
  v_exp_f32 v99, -v99
  s_nop 0
  v_add_f32 v99, 1.0, v99
  v_rcp_f32 v99, v99
  s_nop 0
  v_cvt_pk_bf16_f32 v99, 0, v99
  s_lshl_b32 s56, s55, 2
  s_add_u32 s56, s56, 5328896
  v_mov_b32 v100, 0
  buffer_store_dword v79, v100, s[8:11], s56 offen sc1
  buffer_store_dword v99, v100, s[8:11], s56 offen offset:32 sc1
k_own_nometa:
  s_mov_b64 exec, -1
  s_mov_b32 s50, s54
  s_xor_b32 s51, s51, 1
  s_branch k_own
k_own_done:
  s_andn2_b64 exec, exec, s[52:53]
  buffer_store_dwordx2 v[10:11], v250, s[12:15], 0 offen offset:0
  buffer_store_dwordx2 v[12:13], v250, s[12:15], 0 offen offset:64
  buffer_store_dwordx2 v[14:15], v250, s[12:15], 0 offen offset:128
  buffer_store_dwordx2 v[16:17], v250, s[12:15], 0 offen offset:192
  buffer_store_dwordx2 v[18:19], v250, s[12:15], 0 offen offset:256
  s_mov_b64 exec, -1
  s_cmp_lt_u32 s2, 160
  s_cbranch_scc1 k_end
  v_lshrrev_b32 v7, 4, v1
  s_movk_i32 s46, 1280
  v_mul_lo_u32 v9, v252, s46
  v_lshl_add_u32 v9, v7, 4, v9
  s_mul_i32 s47, s3, 320
  s_add_u32 s47, s47, 5308416
  v_lshlrev_b32 v10, 3, v7
  v_bfe_u32 v11, v1, 2, 2
  v_add_u32 v10, v10, v11
  v_lshlrev_b32 v10, 5, v10
  v_and_b32 v11, 3, v1
  v_lshl_add_u32 v10, v11, 3, v10
  s_mul_i32 s44, s3, 5120
  s_add_u32 s44, s44, 19712
  v_add_u32 v10, s44, v10
  ds_read_b64_tr_b16 v[120:121], v10 offset:0
  ds_read_b64_tr_b16 v[122:123], v10 offset:128
  ds_read_b64_tr_b16 v[140:141], v10 offset:20480
  ds_read_b64_tr_b16 v[142:143], v10 offset:20608
  ds_read_b64_tr_b16 v[124:125], v10 offset:1024
  ds_read_b64_tr_b16 v[126:127], v10 offset:1152
  ds_read_b64_tr_b16 v[144:145], v10 offset:21504
  ds_read_b64_tr_b16 v[146:147], v10 offset:21632
  s_waitcnt lgkmcnt(0)
  ds_read_b64_tr_b16 v[128:129], v10 offset:2048
  ds_read_b64_tr_b16 v[130:131], v10 offset:2176
  ds_read_b64_tr_b16 v[148:149], v10 offset:22528
  ds_read_b64_tr_b16 v[150:151], v10 offset:22656
  ds_read_b64_tr_b16 v[132:133], v10 offset:3072
  ds_read_b64_tr_b16 v[134:135], v10 offset:3200
  ds_read_b64_tr_b16 v[152:153], v10 offset:23552
  ds_read_b64_tr_b16 v[154:155], v10 offset:23680
  s_waitcnt lgkmcnt(0)
  ds_read_b64_tr_b16 v[136:137], v10 offset:4096
  ds_read_b64_tr_b16 v[138:139], v10 offset:4224
  ds_read_b64_tr_b16 v[156:157], v10 offset:24576
  ds_read_b64_tr_b16 v[158:159], v10 offset:24704
  s_mov_b64 s[54:55], -1
  s_sleep 8
  s_mov_b32 s46, 0
zpoll_11:
  s_mov_b64 exec, s[54:55]
  s_cbranch_execz zpoll_11_sk0
  buffer_load_dwordx4 v[40:43], v9, s[8:11], s47 offen offset:0 sc1
  buffer_load_dwordx4 v[44:47], v9, s[8:11], s47 offen offset:64 sc1
  buffer_load_dwordx4 v[48:51], v9, s[8:11], s47 offen offset:128 sc1
  buffer_load_dwordx4 v[52:55], v9, s[8:11], s47 offen offset:192 sc1
  buffer_load_dwordx4 v[56:59], v9, s[8:11], s47 offen offset:256 sc1
zpoll_11_sk0:
  s_mov_b64 exec, -1
  s_waitcnt vmcnt(0)
zpoll_11_chk:
  v_max3_u32 v60, v40, v41, v42
  v_max3_u32 v60, v60, v43, v44
  v_max3_u32 v60, v60, v45, v46
  v_max3_u32 v60, v60, v47, v48
  v_max3_u32 v60, v60, v49, v50
  v_max3_u32 v60, v60, v51, v52
  v_max3_u32 v60, v60, v53, v54
  v_max3_u32 v60, v60, v55, v56
  v_max3_u32 v60, v60, v57, v58
  v_max_u32 v60, v60, v59
  v_cmp_eq_u32 vcc, -1, v60
  s_and_b64 s[54:55], s[54:55], vcc
  s_cmp_eq_u64 s[54:55], 0
  s_cbranch_scc1 zpoll_11_done
  s_add_u32 s46, s46, 1
  s_sleep 1
  s_cmp_lt_u32 s46, 40000
  s_cbranch_scc1 zpoll_11
zpoll_11_done:
  s_waitcnt lgkmcnt(0)
  v_mfma_f32_16x16x32_bf16 v[80:83], v[40:43], v[120:123], 0
  v_mfma_f32_16x16x32_bf16 v[84:87], v[40:43], v[140:143], 0
  v_mfma_f32_16x16x32_bf16 v[80:83], v[44:47], v[124:127], v[80:83]
  v_mfma_f32_16x16x32_bf16 v[84:87], v[44:47], v[144:147], v[84:87]
  v_mfma_f32_16x16x32_bf16 v[80:83], v[48:51], v[128:131], v[80:83]
  v_mfma_f32_16x16x32_bf16 v[84:87], v[48:51], v[148:151], v[84:87]
  v_mfma_f32_16x16x32_bf16 v[80:83], v[52:55], v[132:135], v[80:83]
  v_mfma_f32_16x16x32_bf16 v[84:87], v[52:55], v[152:155], v[84:87]
  v_mfma_f32_16x16x32_bf16 v[80:83], v[56:59], v[136:139], v[80:83]
  v_mfma_f32_16x16x32_bf16 v[84:87], v[56:59], v[156:159], v[84:87]
  v_lshlrev_b32 v11, 4, v1
  s_lshl_b32 s44, s3, 11
  v_add_u32 v12, s44, v11
  s_lshl_b32 s44, s3, 2
  v_add_u32 v11, s44, v11
  s_nop 5
  ds_write_b128 v12, v[80:83] offset:11328
  ds_write_b128 v12, v[84:87] offset:12352
  s_waitcnt lgkmcnt(0)
  s_barrier
  ds_read_b32 v40, v11 offset:11328
  ds_read_b32 v44, v11 offset:12352
  ds_read_b32 v41, v11 offset:13376
  ds_read_b32 v45, v11 offset:14400
  ds_read_b32 v42, v11 offset:15424
  ds_read_b32 v46, v11 offset:16448
  ds_read_b32 v43, v11 offset:17472
  ds_read_b32 v47, v11 offset:18496
  v_and_b32 v13, 15, v1
  v_lshlrev_b32 v12, 1, v13
  v_lshrrev_b32 v7, 4, v1
  s_movk_i32 s46, 12288
  v_mul_lo_u32 v14, v7, s46
  v_add_u32 v12, v12, v14
  s_lshl_b32 s44, s36, 5
  s_mul_i32 s45, s3, 3072
  s_add_u32 s44, s44, s45
  s_add_u32 s44, s44, 5329152
  s_waitcnt lgkmcnt(0)
  v_add_f32 v40, v40, v41
  v_add_f32 v42, v42, v43
  v_add_f32 v44, v44, v45
  v_add_f32 v46, v46, v47
  v_add_f32 v40, v40, v42
  v_add_f32 v44, v44, v46
  v_cvt_pk_bf16_f32 v40, 0, v40
  v_cvt_pk_bf16_f32 v44, 0, v44
  v_mul_f32 v52, 0x3fb8aa3b, v40
  v_exp_f32 v52, -v52
  s_nop 0
  v_add_f32 v52, 1.0, v52
  v_rcp_f32 v52, v52
  s_nop 0
  v_mul_f32 v52, v52, v40
  v_cvt_pk_bf16_f32 v52, 0, v52
  v_mul_f32 v52, v52, v44
  v_cvt_pk_bf16_f32 v52, v52, v52
  s_mov_b32 s58, 0x05040100
  s_nop 0
  v_mov_b32_dpp v53, v52 quad_perm:[1,1,3,3] row_mask:0xf bank_mask:0xf
  v_perm_b32 v56, v53, v52, s58
  s_nop 1
  v_mov_b32_dpp v57, v56 row_shl:2 row_mask:0xf bank_mask:0xf
  v_mov_b32_dpp v58, v56 row_shl:4 row_mask:0xf bank_mask:0xf
  v_mov_b32_dpp v59, v56 row_shl:6 row_mask:0xf bank_mask:0xf
  v_and_b32 v11, 7, v1
  v_cmp_eq_u32 vcc, 0, v11
  v_cmp_gt_u32 s[48:49], 2, v7
  s_and_b64 vcc, vcc, s[48:49]
  s_and_saveexec_b64 s[48:49], vcc
  buffer_store_dwordx4 v[56:59], v12, s[8:11], s44 offen sc1
  s_add_u32 s45, s44, 24576
  buffer_store_dwordx4 v[56:59], v12, s[8:11], s45 offen sc1
  s_add_u32 s45, s44, 49152
  buffer_store_dwordx4 v[56:59], v12, s[8:11], s45 offen sc1
  s_add_u32 s45, s44, 73728
  buffer_store_dwordx4 v[56:59], v12, s[8:11], s45 offen sc1
  s_mov_b64 exec, -1
  s_cmp_ge_u32 s38, 80
  s_cbranch_scc1 k_end
  v_bfe_u32 v5, v1, 3, 1
  v_lshrrev_b32 v7, 4, v1
  s_movk_i32 s46, 3072
  v_mul_lo_u32 v9, v252, s46
  s_movk_i32 s46, 1536
  v_mul_lo_u32 v10, v5, s46
  v_add_u32 v9, v9, v10
  v_lshl_add_u32 v9, v7, 4, v9
  s_mul_i32 s47, s3, 384
  s_and_b32 s46, s2, 3
  s_mul_i32 s46, s46, 24576
  s_add_u32 s47, s47, s46
  s_add_u32 s47, s47, 5329152
  v_lshlrev_b32 v14, 3, v7
  v_bfe_u32 v15, v1, 2, 2
  v_add_u32 v14, v14, v15
  v_bfe_u32 v15, v1, 1, 1
  s_movk_i32 s46, 768
  v_mul_lo_u32 v15, v15, s46
  v_add_u32 v14, v14, v15
  v_lshlrev_b32 v14, 4, v14
  v_and_b32 v15, 1, v1
  v_lshl_add_u32 v14, v15, 3, v14
  s_mul_i32 s44, s3, 3072
  s_add_u32 s44, s44, 60672
  v_add_u32 v14, s44, v14
  ds_read_b64_tr_b16 v[120:121], v14 offset:0
  ds_read_b64_tr_b16 v[122:123], v14 offset:64
  ds_read_b64_tr_b16 v[124:125], v14 offset:512
  ds_read_b64_tr_b16 v[126:127], v14 offset:576
  ds_read_b64_tr_b16 v[128:129], v14 offset:1024
  ds_read_b64_tr_b16 v[130:131], v14 offset:1088
  ds_read_b64_tr_b16 v[132:133], v14 offset:1536
  ds_read_b64_tr_b16 v[134:135], v14 offset:1600
  ds_read_b64_tr_b16 v[136:137], v14 offset:2048
  ds_read_b64_tr_b16 v[138:139], v14 offset:2112
  ds_read_b64_tr_b16 v[140:141], v14 offset:2560
  ds_read_b64_tr_b16 v[142:143], v14 offset:2624
  v_lshrrev_b32 v20, 3, v1
  v_and_b32 v21, 7, v1
  s_movk_i32 s46, 1280
  v_mul_lo_u32 v35, v20, s46
  v_lshl_add_u32 v35, v21, 1, v35
  v_and_b32 v35, 0xfffffffc, v35
  s_lshl_b32 s44, s37, 4
  s_add_u32 s50, s44, 5308416
  s_add_u32 s51, s44, 5318656
  v_lshlrev_b32 v32, 2, v20
  s_mov_b32 s45, 5328896
  s_mov_b64 s[54:55], -1
  s_mov_b64 s[56:57], 0
  s_cmp_lg_u32 s3, 0
  s_cbranch_scc1 k_g2_m
  s_mov_b64 s[56:57], -1
k_g2_m:
  s_sleep 6
  s_mov_b32 s46, 0
hpoll_12:
  s_mov_b64 exec, s[54:55]
  s_cbranch_execz hpoll_12_sk0
  buffer_load_dwordx4 v[40:43], v9, s[8:11], s47 offen offset:0 sc1
  buffer_load_dwordx4 v[44:47], v9, s[8:11], s47 offen offset:64 sc1
  buffer_load_dwordx4 v[48:51], v9, s[8:11], s47 offen offset:128 sc1
  buffer_load_dwordx4 v[52:55], v9, s[8:11], s47 offen offset:192 sc1
  buffer_load_dwordx4 v[56:59], v9, s[8:11], s47 offen offset:256 sc1
  buffer_load_dwordx4 v[60:63], v9, s[8:11], s47 offen offset:320 sc1
hpoll_12_sk0:
  s_mov_b64 exec, s[56:57]
  s_cbranch_execz hpoll_12_sk1
  buffer_load_dword v36, v35, s[8:11], s50 offen sc1
  buffer_load_dword v37, v35, s[8:11], s51 offen sc1
  buffer_load_dword v33, v32, s[8:11], s45 offen sc1
  buffer_load_dword v34, v32, s[8:11], s45 offen offset:32 sc1
hpoll_12_sk1:
  s_mov_b64 exec, -1
  s_waitcnt vmcnt(0)
hpoll_12_chk:
  v_max3_u32 v65, v40, v41, v42
  v_max3_u32 v65, v65, v43, v44
  v_max3_u32 v65, v65, v45, v46
  v_max3_u32 v65, v65, v47, v48
  v_max3_u32 v65, v65, v49, v50
  v_max3_u32 v65, v65, v51, v52
  v_max3_u32 v65, v65, v53, v54
  v_max3_u32 v65, v65, v55, v56
  v_max3_u32 v65, v65, v57, v58
  v_max3_u32 v65, v65, v59, v60
  v_max3_u32 v65, v65, v61, v62
  v_max_u32 v65, v65, v63
  v_cmp_eq_u32 vcc, -1, v65
  s_and_b64 s[54:55], s[54:55], vcc
  v_max3_u32 v64, v36, v37, v33
  v_max_u32 v64, v64, v34
  v_cmp_eq_u32 vcc, -1, v64
  s_and_b64 s[56:57], s[56:57], vcc
  s_or_b64 vcc, s[54:55], s[56:57]
  s_cmp_eq_u64 vcc, 0
  s_cbranch_scc1 hpoll_12_done
  s_add_u32 s46, s46, 1
  s_sleep 1
  s_cmp_lt_u32 s46, 40000
  s_cbranch_scc1 hpoll_12
hpoll_12_done:
  s_waitcnt lgkmcnt(0)
  v_mfma_f32_16x16x32_bf16 v[88:91], v[40:43], v[120:123], 0
  v_mfma_f32_16x16x32_bf16 v[88:91], v[44:47], v[124:127], v[88:91]
  v_mfma_f32_16x16x32_bf16 v[88:91], v[48:51], v[128:131], v[88:91]
  v_mfma_f32_16x16x32_bf16 v[88:91], v[52:55], v[132:135], v[88:91]
  v_mfma_f32_16x16x32_bf16 v[88:91], v[56:59], v[136:139], v[88:91]
  v_mfma_f32_16x16x32_bf16 v[88:91], v[60:63], v[140:143], v[88:91]
  v_lshlrev_b32 v15, 4, v1
  s_lshl_b32 s44, s3, 10
  v_add_u32 v16, s44, v15
  s_barrier
  s_nop 4
  ds_write_b128 v16, v[88:91] offset:11328
  s_waitcnt lgkmcnt(0)
  s_barrier
  s_cmp_lg_u32 s3, 0
  s_cbranch_scc1 k_end
  v_lshrrev_b32 v22, 2, v20
  v_lshl_add_u32 v22, v22, 4, v21
  v_lshlrev_b32 v22, 4, v22
  v_and_b32 v23, 3, v20
  v_lshl_add_u32 v22, v23, 2, v22
  ds_read_b32 v24, v22 offset:11328
  ds_read_b32 v25, v22 offset:11968
  ds_read_b32 v26, v22 offset:12352
  ds_read_b32 v27, v22 offset:12992
  ds_read_b32 v28, v22 offset:13376
  ds_read_b32 v29, v22 offset:14016
  ds_read_b32 v30, v22 offset:14400
  ds_read_b32 v31, v22 offset:15040
  v_and_b32 v38, 1, v21
  v_cmp_eq_u32 vcc, 1, v38
  v_lshlrev_b32 v38, 16, v36
  v_and_b32 v36, 0xffff0000, v36
  v_cndmask_b32 v36, v38, v36, vcc
  v_lshlrev_b32 v38, 16, v37
  v_and_b32 v37, 0xffff0000, v37
  v_cndmask_b32 v37, v38, v37, vcc
  s_movk_i32 s46, 1280
  v_mul_lo_u32 v35, v33, s46
  v_lshl_add_u32 v35, v21, 1, v35
  s_lshl_b32 s44, s37, 4
  s_waitcnt lgkmcnt(0)
  v_add_f32 v24, v24, v25
  v_add_f32 v26, v26, v27
  v_add_f32 v28, v28, v29
  v_add_f32 v30, v30, v31
  v_add_f32 v24, v24, v26
  v_add_f32 v28, v28, v30
  v_add_f32 v24, v24, v28
  v_cvt_pk_bf16_f32 v24, 0, v24
  v_mul_f32 v24, v24, v34
  v_cvt_pk_bf16_f32 v24, 0, v24
  v_add_f32 v24, v36, v24
  v_cvt_pk_bf16_f32 v24, 0, v24
  v_add_f32 v24, v37, v24
  v_cvt_pk_bf16_f32 v24, v24, v24
  buffer_store_short v24, v35, s[12:15], s44 offen
k_end:
k_exit:
  s_endpgm
k_code_end:
  s_endpgm
.section .rodata,"a"
.p2align 6
.amdhsa_kernel sequential_preLN__ssm_conv_s4d__moe_arch_mod__prompt_kernel
  .amdhsa_next_free_vgpr 512
  .amdhsa_next_free_sgpr 100
  .amdhsa_accum_offset 256
  .amdhsa_group_segment_fixed_size 0
  .amdhsa_kernarg_size 120
  .amdhsa_user_sgpr_count 2
  .amdhsa_user_sgpr_kernarg_segment_ptr 1
  .amdhsa_system_sgpr_workgroup_id_x 1
.end_amdhsa_kernel
```
